```python
import torch

def _softmax(x, axis=-1):
    return torch.softmax(x, dim=axis)
def _gelu(x):
    return torch.nn.functional.gelu(x, approximate="tanh")
def _silu(x):
    return torch.nn.functional.silu(x)
def _sigmoid(x):
    return torch.sigmoid(x)
def _layernorm(x, axis=-1, eps=1e-5):
    m = x.mean(dim=axis, keepdim=True)
    v = x.var(dim=axis, keepdim=True, unbiased=False)
    return (x - m) / torch.sqrt(v + eps)
def _scatter_add(tgt, idx, src, axis=0):
    return tgt.clone().index_add_(axis, idx, src)
def _segment_sum(src, seg, n):
    out = torch.zeros((n,) + src.shape[1:], dtype=src.dtype)
    return out.index_add_(0, seg, src)
def _pad(x, pw):
    flat = tuple(v for pair in reversed(pw) for v in pair)
    return torch.nn.functional.pad(x, flat)

kernel_name = 'standalone__gqa_block_cached__near_ridge'

def setup_inputs():

    _w = (lambda a: (lambda t: t.to(torch.bfloat16) if t.is_floating_point() else t)(torch.as_tensor(a)))
    B, Sq, D = 8, 80, 512
    Hq, Hkv, Sk, Dh = 32, 8, 1024, 128
    assert Hq % Hkv == 0, (Hq, Hkv)
    return {
        "x": _w((lambda *s: torch.randn(*s, dtype=torch.bfloat16) * 0.8)(B, Sq, D)),
        "k_cache": _w((lambda *s: torch.randn(*s, dtype=torch.bfloat16) * 0.8)(B, Hkv, Sk, Dh)),
        "v_cache": _w((lambda *s: torch.randn(*s, dtype=torch.bfloat16) * 0.05)(B, Hkv, Sk, Dh)),
        "wq": _w((lambda *s: torch.randn(*s, dtype=torch.bfloat16) * 0.8)(D, Hq * Dh) * (D ** -0.5)),
        "wo": _w((lambda *s: torch.randn(*s, dtype=torch.bfloat16) * 0.05)(Hq * Dh, D) * ((Hq * Dh) ** -0.5)),
    }

def reference(x, k_cache, v_cache, wq, wo):
    B, Sq, D = x.shape
    Hq, Dh = 32, 128
    Hkv = k_cache.shape[1]
    rep = Hq // Hkv
    q = (lambda x, *d: x.permute(*d))((x @ wq).reshape(B, Sq, Hq, Dh), 0, 2, 1, 3)
    k = (lambda x, n, axis: torch.repeat_interleave(x, n, dim=axis))(k_cache, rep, axis=1)
    v = (lambda x, n, axis: torch.repeat_interleave(x, n, dim=axis))(v_cache, rep, axis=1)
    scores = torch.einsum("bhqd,bhkd->bhqk", q, k) * (Dh ** -0.5)
    p = _softmax(scores, axis=-1)
    o = torch.einsum("bhqk,bhkd->bhqd", p, v)
    return (lambda x, *d: x.permute(*d))(o, 0, 2, 1, 3).reshape(B, Sq, Hq * Dh) @ wo
```

```asm
; @launch grid=(256,1,1) block=(256,1,1) lds=163840
.amdgcn_target "amdgcn-amd-amdhsa--gfx950"
.text
.globl standalone__gqa_block_cached__near_ridge_kernel
.p2align 8
.type standalone__gqa_block_cached__near_ridge_kernel,@function
standalone__gqa_block_cached__near_ridge_kernel:
    s_cmp_ge_u32 s2, 256
    s_cbranch_scc1 L_end
    s_load_dwordx2 s[92:93], s[0:1], 0
    s_load_dwordx2 s[26:27], s[0:1], 24
    s_getpc_b64 s[94:95]
L_pc:
    s_lshr_b32 s3, s2, 3
    v_lshrrev_b32 v8, 6, v0
    v_and_b32 v9, 1, v0
    v_lshl_add_u32 v8, v8, 1, v9
    v_lshl_add_u32 v8, s3, 3, v8
    v_lshlrev_b32 v8, 7, v8
    v_min_u32 v8, (L_code_end - L_pc - 4) & 0xffffff80, v8
    global_load_dword v255, v8, s[94:95]
    v_lshrrev_b32 v4, 6, v0
    v_and_b32 v1, 63, v0
    v_readfirstlane_b32 s32, v4
    s_and_b32 s34, s2, 7
    s_lshr_b32 s33, s2, 5
    s_bfe_u32 s39, s2, 0x20003
    s_mov_b32 s69, s39
    s_lshl_b32 s35, s34, 2
    s_add_u32 s35, s35, s39
    s_add_u32 s71, s39, s33
    s_lshl_b32 s71, s71, 1
    s_and_b32 s40, s34, 1
    s_add_u32 s71, s71, s40
    s_and_b32 s71, s71, 3
    s_lshl_b32 s71, s71, 1
    v_and_b32 v2, 15, v1
    v_lshrrev_b32 v3, 4, v1
    s_lshl_b32 s36, s32, 10
    s_lshl_b32 s37, s32, 13
    v_lshl_add_u32 v4, s32, 2, v3
    v_xor_b32 v5, v2, v4
    v_lshlrev_b32 v5, 4, v5
    v_lshl_add_u32 v84, v4, 10, v5
    s_and_b32 s39, s32, 2
    s_lshl_b32 s39, s39, 2
    v_lshl_add_u32 v5, v3, 1, s39
    v_xor_b32 v5, v2, v5
    v_lshlrev_b32 v5, 4, v5
    v_lshl_add_u32 v85, v4, 13, v5
    s_mul_i32 s39, s33, 81920
    s_lshl_b32 s41, s35, 8
    s_sub_u32 s40, 4194304, s41
    s_mov_b32 s68, 0
    s_lshl_b32 s99, s71, 19
    s_mov_b64 s[70:71], -1
    s_mov_b32 s44, 0
    s_mov_b32 s45, 16384
    s_mov_b32 s46, 32768
    s_mov_b32 s47, 49152
    s_mov_b32 s48, 65536
    s_lshr_b32 s38, s99, 12
    s_add_u32 s38, s38, 0
    s_and_b32 s38, s38, 0x300
    v_add_u32 v204, s38, v84
    s_lshr_b32 s38, s99, 12
    s_add_u32 s38, s38, 256
    s_and_b32 s38, s38, 0x300
    v_add_u32 v205, s38, v84
    s_lshr_b32 s38, s99, 12
    s_add_u32 s38, s38, 512
    s_and_b32 s38, s38, 0x300
    v_add_u32 v206, s38, v84
    s_lshr_b32 s38, s99, 12
    s_add_u32 s38, s38, 768
    s_and_b32 s38, s38, 0x300
    v_add_u32 v207, s38, v84
    s_mov_b32 s6, 81920
    s_mov_b32 s7, 0x20000
    s_mov_b32 s10, s40
    s_mov_b32 s11, 0x20000
    s_waitcnt lgkmcnt(0)
    s_add_u32 s4, s92, s39
    s_addc_u32 s5, s93, 0
    s_add_u32 s8, s26, s41
    s_addc_u32 s9, s27, 0
    s_load_dwordx2 s[12:13], s[0:1], 8
    s_load_dwordx2 s[16:17], s[0:1], 16
    s_load_dwordx2 s[24:25], s[0:1], 32
    s_load_dwordx2 s[64:65], s[0:1], 40
    s_load_dwordx2 s[60:61], s[0:1], 48
    s_load_dwordx2 s[20:21], s[0:1], 56
    s_add_u32 m0, s36, 0
    s_nop 0
    buffer_load_dwordx4 v204, s[4:7], s44 offen offset:0 lds
    s_add_u32 m0, s36, 4096
    s_nop 0
    buffer_load_dwordx4 v204, s[4:7], s45 offen offset:0 lds
    s_add_u32 m0, s36, 8192
    s_nop 0
    buffer_load_dwordx4 v204, s[4:7], s46 offen offset:0 lds
    s_add_u32 m0, s36, 12288
    s_nop 0
    buffer_load_dwordx4 v204, s[4:7], s47 offen offset:0 lds
    s_add_u32 m0, s36, 16384
    s_nop 0
    buffer_load_dwordx4 v204, s[4:7], s48 offen offset:0 lds
    s_add_u32 s42, s99, 0
    s_and_b32 s42, s42, 3670016
    s_add_u32 s38, s42, 0
    s_add_u32 m0, s36, 40960
    s_nop 0
    buffer_load_dwordx4 v85, s[8:11], s38 offen offset:0 lds
    s_add_u32 s38, s42, 131072
    s_add_u32 m0, s36, 45056
    s_nop 0
    buffer_load_dwordx4 v85, s[8:11], s38 offen offset:0 lds
    s_add_u32 s38, s42, 262144
    s_add_u32 m0, s36, 49152
    s_nop 0
    buffer_load_dwordx4 v85, s[8:11], s38 offen offset:0 lds
    s_add_u32 s38, s42, 393216
    s_add_u32 m0, s36, 53248
    s_nop 0
    buffer_load_dwordx4 v85, s[8:11], s38 offen offset:0 lds
    s_waitcnt lgkmcnt(0)
    s_lshl_b32 s39, s33, 3
    s_add_u32 s39, s39, s34
    s_lshl_b32 s39, s39, 2
    s_add_u32 s39, s39, s32
    s_lshl_b32 s39, s39, 16
    s_add_u32 s12, s12, s39
    s_addc_u32 s13, s13, 0
    s_mov_b32 s14, 65536
    s_mov_b32 s15, 0x20000
    s_add_u32 s16, s16, s39
    s_addc_u32 s17, s17, 0
    s_mov_b32 s18, 65536
    s_mov_b32 s19, 0x20000
    s_lshl_b32 s39, s34, 19
    s_add_u32 s24, s24, s39
    s_addc_u32 s25, s25, 0
    s_mov_b32 s26, 524288
    s_mov_b32 s27, 0x20000
    s_add_u32 s28, s20, 8388608
    s_addc_u32 s29, s21, 0
    s_mov_b32 s30, 5242880
    s_mov_b32 s31, 0x20000
    s_add_u32 s56, s20, 14680064
    s_addc_u32 s57, s21, 0
    s_mov_b32 s58, 262144
    s_mov_b32 s59, 0x20000
    s_mov_b32 s22, 5242880
    s_mov_b32 s23, 0x20000
    s_mov_b32 s62, 256
    s_mov_b32 s63, 0x20000
    s_mov_b32 s66, 655360
    s_mov_b32 s67, 0x20000
    s_bitcmp1_b32 s35, 0
    s_mov_b32 s39, 0x76534210
    s_cselect_b32 s39, 0x76453201, s39
    s_mov_b32 s40, 0x75643102
    s_cselect_b32 s40, 0x67542310, s40
    s_bitcmp1_b32 s35, 1
    s_cselect_b32 s98, s40, s39
    s_cmp_le_u32 s69, 0
    s_cselect_b32 s40, 1, 0
    s_lshl_b32 s52, s40, 17
    s_cmp_le_u32 s69, 1
    s_cselect_b32 s40, 2, 1
    s_lshl_b32 s53, s40, 17
    s_cmp_le_u32 s69, 2
    s_cselect_b32 s40, 3, 2
    s_lshl_b32 s54, s40, 17
    s_mul_i32 s55, s32, 5120
    s_lshl_b32 s39, s33, 14
    s_lshl_b32 s40, s32, 7
    s_add_u32 s39, s39, s40
    s_lshl_b32 s100, s35, 9
    s_add_u32 s100, s100, s39
    s_add_u32 s101, s100, 131072
    s_lshl_b32 s40, s34, 11
    s_lshl_b32 s72, s69, 3
    s_add_u32 s72, s72, s40
    s_add_u32 s72, s72, s39
    s_lshl_b32 s40, s69, 9
    s_lshl_b32 s51, s34, 3
    s_add_u32 s51, s51, s40
    s_add_u32 s51, s51, s39
    s_add_u32 s51, s51, 131072
    s_cmp_lg_u32 s2, 0
    s_cbranch_scc1 L_nocz
    s_cmp_lg_u32 s32, 0
    s_cbranch_scc1 L_nocz
    s_mov_b64 s[74:75], exec
    s_mov_b64 exec, 1
    v_mov_b32 v9, 0
    s_memrealtime s[96:97]
    s_waitcnt lgkmcnt(0)
    s_or_b32 s96, s96, 1
    v_mov_b32 v250, s96
    v_mov_b32 v251, s97
    buffer_store_dwordx2 v[250:251], v9, s[60:63], 0 offen sc1
    s_mov_b64 exec, s[74:75]
L_nocz:
    s_branch L_first
L_restart:
    s_mov_b32 s44, 0
    s_mov_b32 s45, 16384
    s_mov_b32 s46, 32768
    s_mov_b32 s47, 49152
    s_mov_b32 s48, 65536
    s_lshr_b32 s38, s99, 12
    s_add_u32 s38, s38, 0
    s_and_b32 s38, s38, 0x300
    v_add_u32 v204, s38, v84
    s_lshr_b32 s38, s99, 12
    s_add_u32 s38, s38, 256
    s_and_b32 s38, s38, 0x300
    v_add_u32 v205, s38, v84
    s_lshr_b32 s38, s99, 12
    s_add_u32 s38, s38, 512
    s_and_b32 s38, s38, 0x300
    v_add_u32 v206, s38, v84
    s_lshr_b32 s38, s99, 12
    s_add_u32 s38, s38, 768
    s_and_b32 s38, s38, 0x300
    v_add_u32 v207, s38, v84
    s_add_u32 m0, s36, 0
    s_nop 0
    buffer_load_dwordx4 v204, s[4:7], s44 offen offset:0 lds
    s_add_u32 m0, s36, 4096
    s_nop 0
    buffer_load_dwordx4 v204, s[4:7], s45 offen offset:0 lds
    s_add_u32 m0, s36, 8192
    s_nop 0
    buffer_load_dwordx4 v204, s[4:7], s46 offen offset:0 lds
    s_add_u32 m0, s36, 12288
    s_nop 0
    buffer_load_dwordx4 v204, s[4:7], s47 offen offset:0 lds
    s_add_u32 m0, s36, 16384
    s_nop 0
    buffer_load_dwordx4 v204, s[4:7], s48 offen offset:0 lds
    s_add_u32 s42, s99, 0
    s_and_b32 s42, s42, 3670016
    s_add_u32 s38, s42, 0
    s_add_u32 m0, s36, 40960
    s_nop 0
    buffer_load_dwordx4 v85, s[8:11], s38 offen offset:0 lds
    s_add_u32 s38, s42, 131072
    s_add_u32 m0, s36, 45056
    s_nop 0
    buffer_load_dwordx4 v85, s[8:11], s38 offen offset:0 lds
    s_add_u32 s38, s42, 262144
    s_add_u32 m0, s36, 49152
    s_nop 0
    buffer_load_dwordx4 v85, s[8:11], s38 offen offset:0 lds
    s_add_u32 s38, s42, 393216
    s_add_u32 m0, s36, 53248
    s_nop 0
    buffer_load_dwordx4 v85, s[8:11], s38 offen offset:0 lds
L_first:
    s_add_u32 s42, s99, 0
    s_and_b32 s42, s42, 3670016
    s_xor_b32 s42, s42, 524288
    s_add_u32 s38, s42, 0
    s_add_u32 m0, s36, 57344
    s_nop 0
    buffer_load_dwordx4 v85, s[8:11], s38 offen offset:0 lds
    s_bfe_u32 s40, s99, 0x10013
    s_lshl_b32 s40, s40, 3
    v_xor_b32 v5, s40, v2
    v_xor_b32 v4, v3, v5
    v_lshlrev_b32 v4, 4, v4
    v_lshl_add_u32 v76, v2, 8, v4
    v_xor_b32 v77, 64, v76
    v_xor_b32 v78, 128, v76
    v_xor_b32 v79, 192, v76
    v_add_u32 v56, 122880, v76
    v_add_u32 v57, 122880, v77
    v_add_u32 v58, 122880, v78
    v_add_u32 v59, 122880, v79
    v_lshrrev_b32 v6, 2, v2
    s_add_u32 s38, s42, 131072
    s_add_u32 m0, s36, 61440
    s_nop 0
    buffer_load_dwordx4 v85, s[8:11], s38 offen offset:0 lds
    v_bfe_u32 v7, v2, 1, 1
    v_and_b32 v8, 1, v2
    v_lshlrev_b32 v8, 3, v8
    v_and_b32 v9, 1, v3
    v_lshl_add_u32 v9, v9, 2, v6
    v_lshlrev_b32 v9, 1, v9
    s_lshl_b32 s40, s32, 2
    v_lshl_add_u32 v5, v3, 3, v6
    v_lshl_add_u32 v5, v5, 8, v8
    v_add_u32 v7, s40, v7
    v_xor_b32 v7, v7, v9
    v_lshl_add_u32 v4, v7, 4, v5
    v_add_u32 v80, 40960, v4
    v_add_u32 v82, 98304, v4
    s_add_u32 s38, s42, 262144
    s_add_u32 m0, s36, 98304
    s_nop 0
    buffer_load_dwordx4 v85, s[8:11], s38 offen offset:0 lds
    v_xor_b32 v81, 32, v80
    v_xor_b32 v83, 32, v82
    v_lshl_add_u32 v5, v3, 2, v6
    v_add_u32 v10, s37, v76
    v_add_u32 v11, s37, v77
    v_add_u32 v12, s37, v78
    v_add_u32 v13, s37, v79
    v_lshl_add_u32 v5, v5, 8, v8
    v_lshl_add_u32 v236, v7, 4, v5
    s_add_u32 s41, s37, 65536
    v_add_u32 v14, s41, v236
    v_xor_b32 v15, 32, v14
    v_xor_b32 v16, 64, v14
    v_xor_b32 v17, 96, v14
    s_add_u32 s38, s42, 393216
    s_add_u32 m0, s36, 102400
    s_nop 0
    buffer_load_dwordx4 v85, s[8:11], s38 offen offset:0 lds
    v_xor_b32 v18, 128, v14
    v_xor_b32 v19, 160, v14
    v_xor_b32 v20, 192, v14
    v_xor_b32 v21, 224, v14
    v_xor_b32 v237, 32, v236
    v_add_u32 v238, 65536, v236
    v_add_u32 v240, 131072, v236
    v_add_u32 v239, 65536, v237
    v_add_u32 v241, 131072, v237
    v_xor_b32 v4, v2, v3
    v_lshlrev_b32 v4, 4, v4
    v_lshl_add_u32 v22, v3, 8, v4
    v_xor_b32 v23, 64, v22
    v_xor_b32 v24, 128, v22
    s_add_u32 m0, s36, 20480
    s_nop 0
    buffer_load_dwordx4 v205, s[4:7], s44 offen offset:0 lds
    v_xor_b32 v25, 192, v22
    v_lshlrev_b32 v4, 1, v3
    v_xor_b32 v4, v2, v4
    v_lshlrev_b32 v4, 4, v4
    v_lshl_add_u32 v26, v3, 8, v4
    v_xor_b32 v27, 128, v26
    v_lshrrev_b32 v4, 1, v3
    v_add_u32 v4, s40, v4
    v_xor_b32 v4, v4, v2
    v_lshlrev_b32 v4, 4, v4
    v_lshl_add_u32 v4, v2, 8, v4
    v_and_b32 v5, 1, v3
    v_lshl_add_u32 v4, v5, 3, v4
    v_add_u32 v86, 131072, v4
    s_add_u32 m0, s36, 24576
    s_nop 0
    buffer_load_dwordx4 v205, s[4:7], s45 offen offset:0 lds
    v_xor_b32 v87, 32, v86
    v_lshl_add_u32 v29, v1, 4, s37
    v_add_u32 v30, 65536, v29
    s_add_u32 s39, s37, 104448
    v_lshl_add_u32 v31, v1, 5, s39
    s_mul_i32 s39, s33, 640
    s_lshl_b32 s41, s35, 2
    s_add_u32 s39, s39, s41
    s_add_u32 s39, s39, s32
    s_lshl_b32 s39, s39, 10
    v_lshl_add_u32 v28, v1, 4, s39
    v_cmp_eq_u32 vcc, 0, v2
    v_mov_b32 v4, 0x3f803f80
    s_nop 0
    v_cndmask_b32 v32, 0, v4, vcc
    s_add_u32 m0, s36, 28672
    s_nop 0
    buffer_load_dwordx4 v205, s[4:7], s46 offen offset:0 lds
    v_cndmask_b32 v33, 0, v4, vcc
    v_cndmask_b32 v34, 0, v4, vcc
    v_cndmask_b32 v35, 0, v4, vcc
    v_mov_b64 v[36:37], 0
    v_mov_b64 v[38:39], 0
    v_mov_b64 v[40:41], 0
    v_mov_b64 v[42:43], 0
    v_mov_b64 v[44:45], 0
    v_mov_b64 v[46:47], 0
    v_mov_b64 v[48:49], 0
    v_mov_b64 v[50:51], 0
    v_mov_b64 v[52:53], 0
    v_mov_b64 v[54:55], 0
    s_lshl_b32 s39, s69, 12
    s_add_u32 m0, s36, 32768
    s_nop 0
    buffer_load_dwordx4 v205, s[4:7], s47 offen offset:0 lds
    v_subrev_u32 v244, s39, v28
    s_lshl_b32 s39, s33, 2
    s_add_u32 s39, s39, s69
    s_mul_i32 s39, s39, 163840
    s_mul_i32 s40, s32, 40960
    s_lshl_b32 s41, s34, 10
    s_add_u32 s41, s41, s40
    s_add_u32 s41, s41, s39
    v_lshl_add_u32 v245, v1, 4, s41
    s_mul_i32 s40, s34, 160
    v_add_u32 v252, s40, v0
    v_bfe_u32 v253, v252, 5, 1
    v_and_b32 v254, 7, v252
    v_lshl_add_u32 v253, v253, 3, v254
    s_add_u32 m0, s36, 36864
    s_nop 0
    buffer_load_dwordx4 v205, s[4:7], s48 offen offset:0 lds
    v_bfe_u32 v254, v252, 3, 2
    v_lshrrev_b32 v252, 6, v252
    v_lshl_add_u32 v9, v254, 4, v253
    v_lshl_add_u32 v246, v9, 4, s39
    v_lshl_add_u32 v246, v252, 13, v246
    v_mul_u32_u24 v9, 52, v252
    v_lshrrev_b32 v9, 8, v9
    v_and_b32 v253, 8, v253
    v_bfe_u32 v254, v0, 2, 3
    v_add_u32 v253, v253, v254
    v_and_b32 v254, 3, v0
    v_lshlrev_b32 v254, 4, v254
    v_lshl_add_u32 v254, v9, 6, v254
    v_lshl_add_u32 v254, v253, 10, v254
    s_add_u32 s42, s99, 1048576
    s_and_b32 s42, s42, 3670016
    s_add_u32 s38, s42, 0
    s_add_u32 m0, s36, 106496
    s_nop 0
    buffer_load_dwordx4 v85, s[8:11], s38 offen offset:0 lds
    v_mul_u32_u24 v9, 5, v9
    v_sub_u32 v252, v252, v9
    v_lshl_add_u32 v254, v252, 14, v254
    s_mul_i32 s39, s33, 81920
    s_lshl_b32 s41, s69, 8
    s_add_u32 s39, s39, s41
    v_add_u32 v247, s39, v254
    v_cmp_gt_u32 vcc, 160, v0
    v_mov_b32 v252, 0x7ff00000
    s_nop 0
    v_cndmask_b32 v246, v252, v246, vcc
    v_cndmask_b32 v247, v252, v247, vcc
    v_lshl_add_u32 v248, v1, 9, s72
    v_cmp_gt_u32 vcc, 4, v1
    s_nop 1
    v_cndmask_b32 v248, v252, v248, vcc
    s_add_u32 s38, s42, 131072
    s_add_u32 m0, s36, 110592
    s_nop 0
    buffer_load_dwordx4 v85, s[8:11], s38 offen offset:0 lds
    v_and_b32 v253, 7, v1
    v_lshl_add_u32 v249, v253, 11, s51
    v_lshrrev_b32 v253, 3, v1
    v_lshl_add_u32 v249, v253, 7, v249
    v_cmp_gt_u32 vcc, 24, v1
    s_nop 1
    v_cndmask_b32 v249, v252, v249, vcc
    s_lshl_b32 s39, s33, 2
    s_add_u32 s39, s39, s32
    s_lshl_b32 s39, s39, 14
    s_lshl_b32 s41, s69, 8
    s_add_u32 s39, s39, s41
    v_bfe_u32 v252, v1, 1, 4
    v_and_b32 v253, 1, v1
    v_lshlrev_b32 v253, 7, v253
    s_add_u32 s38, s42, 262144
    s_add_u32 m0, s36, 114688
    s_nop 0
    buffer_load_dwordx4 v85, s[8:11], s38 offen offset:0 lds
    v_lshl_add_u32 v252, v252, 10, v253
    v_add_u32 v64, s39, v252
    s_and_b32 s39, s32, 1
    s_lshl_b32 s39, s39, 3
    v_lshl_add_u32 v252, v3, 1, s39
    v_xor_b32 v252, v2, v252
    s_lshl_b32 s39, s69, 8
    v_lshl_add_u32 v252, v252, 4, s39
    v_lshl_add_u32 v253, s32, 2, v3
    v_lshl_add_u32 v235, v253, 10, v252
    v_lshlrev_b32 v252, 4, v1
    v_xor_b32 v228, 8192, v29
    v_xor_b32 v229, 8192, v30
    v_xor_b32 v230, 16384, v29
    s_add_u32 s38, s42, 393216
    s_add_u32 m0, s36, 118784
    s_nop 0
    buffer_load_dwordx4 v85, s[8:11], s38 offen offset:0 lds
    v_xor_b32 v231, 16384, v30
    v_xor_b32 v232, 24576, v29
    v_xor_b32 v233, 24576, v30
    v_add_u32 v242, 98304, v252
    v_add_u32 v243, s55, v242
    s_mov_b32 s39, 104448
    v_lshl_add_u32 v234, v2, 5, s39
    s_waitcnt vmcnt(13)
    s_barrier
    ds_read_b64_tr_b16 v[120:121], v80 offset:0
    ds_read_b64_tr_b16 v[122:123], v80 offset:1024
    ds_read_b128 v[100:103], v76 offset:0
    ds_read_b64_tr_b16 v[124:125], v81 offset:0
    ds_read_b64_tr_b16 v[126:127], v81 offset:1024
    ds_read_b128 v[104:107], v76 offset:4096
    ds_read_b128 v[108:111], v76 offset:8192
    ds_read_b128 v[112:115], v76 offset:12288
    ds_read_b128 v[116:119], v76 offset:16384
    ds_read_b64_tr_b16 v[148:149], v80 offset:8192
    ds_read_b64_tr_b16 v[150:151], v80 offset:9216
    ds_read_b128 v[128:131], v77 offset:0
    ds_read_b64_tr_b16 v[152:153], v81 offset:8192
    ds_read_b64_tr_b16 v[154:155], v81 offset:9216
    ds_read_b128 v[132:135], v77 offset:4096
    ds_read_b128 v[136:139], v77 offset:8192
    ds_read_b128 v[140:143], v77 offset:12288
    ds_read_b128 v[144:147], v77 offset:16384
    s_mov_b32 s40, 0x3e0293ee
    s_mov_b32 s41, 0x3e0293ee
    s_add_u32 s42, s99, 1048576
    s_and_b32 s42, s42, 3670016
    s_xor_b32 s42, s42, 524288
    s_add_u32 s38, s42, 0
    s_add_u32 m0, s36, 65536
    s_nop 0
    buffer_load_dwordx4 v85, s[8:11], s38 offen offset:0 lds
    s_waitcnt vmcnt(10)
    s_barrier
    s_waitcnt lgkmcnt(9)
    v_mfma_f32_16x16x32_bf16 v[164:167], v[120:123], v[100:103], 0
    s_add_u32 s38, s42, 131072
    s_add_u32 m0, s36, 69632
    ds_read_b64_tr_b16 v[156:157], v80 offset:16384
    v_mfma_f32_16x16x32_bf16 v[184:187], v[124:127], v[100:103], 0
    buffer_load_dwordx4 v85, s[8:11], s38 offen offset:0 lds
    ds_read_b64_tr_b16 v[158:159], v80 offset:17408
    v_mfma_f32_16x16x32_bf16 v[168:171], v[120:123], v[104:107], 0
    s_add_u32 s38, s42, 262144
    ds_read_b128 v[208:211], v78 offset:0
    v_mfma_f32_16x16x32_bf16 v[188:191], v[124:127], v[104:107], 0
    s_add_u32 m0, s36, 73728
    ds_read_b64_tr_b16 v[160:161], v81 offset:16384
    v_mfma_f32_16x16x32_bf16 v[172:175], v[120:123], v[108:111], 0
    buffer_load_dwordx4 v85, s[8:11], s38 offen offset:0 lds
    ds_read_b64_tr_b16 v[162:163], v81 offset:17408
    v_mfma_f32_16x16x32_bf16 v[192:195], v[124:127], v[108:111], 0
    s_add_u32 s38, s42, 393216
    ds_read_b128 v[212:215], v78 offset:4096
    v_mfma_f32_16x16x32_bf16 v[176:179], v[120:123], v[112:115], 0
    s_add_u32 m0, s36, 77824
    ds_read_b128 v[216:219], v78 offset:8192
    v_mfma_f32_16x16x32_bf16 v[196:199], v[124:127], v[112:115], 0
    buffer_load_dwordx4 v85, s[8:11], s38 offen offset:0 lds
    ds_read_b128 v[220:223], v78 offset:12288
    v_mfma_f32_16x16x32_bf16 v[180:183], v[120:123], v[116:119], 0
    ds_read_b128 v[224:227], v78 offset:16384
    v_mfma_f32_16x16x32_bf16 v[200:203], v[124:127], v[116:119], 0
    s_waitcnt lgkmcnt(9)
    v_mfma_f32_16x16x32_bf16 v[164:167], v[148:151], v[128:131], v[164:167]
    s_add_u32 m0, s36, 131072
    ds_read_b64_tr_b16 v[120:121], v82 offset:0
    v_mfma_f32_16x16x32_bf16 v[184:187], v[152:155], v[128:131], v[184:187]
    buffer_load_dwordx4 v206, s[4:7], s44 offen offset:0 lds
    ds_read_b64_tr_b16 v[122:123], v82 offset:1024
    v_mfma_f32_16x16x32_bf16 v[168:171], v[148:151], v[132:135], v[168:171]
    ds_read_b128 v[100:103], v79 offset:0
    v_mfma_f32_16x16x32_bf16 v[188:191], v[152:155], v[132:135], v[188:191]
    s_add_u32 m0, s36, 135168
    ds_read_b64_tr_b16 v[124:125], v83 offset:0
    v_mfma_f32_16x16x32_bf16 v[172:175], v[148:151], v[136:139], v[172:175]
    buffer_load_dwordx4 v206, s[4:7], s45 offen offset:0 lds
    ds_read_b64_tr_b16 v[126:127], v83 offset:1024
    v_mfma_f32_16x16x32_bf16 v[192:195], v[152:155], v[136:139], v[192:195]
    ds_read_b128 v[104:107], v79 offset:4096
    v_mfma_f32_16x16x32_bf16 v[176:179], v[148:151], v[140:143], v[176:179]
    ds_read_b128 v[108:111], v79 offset:8192
    v_mfma_f32_16x16x32_bf16 v[196:199], v[152:155], v[140:143], v[196:199]
    s_add_u32 m0, s36, 139264
    ds_read_b128 v[112:115], v79 offset:12288
    v_mfma_f32_16x16x32_bf16 v[180:183], v[148:151], v[144:147], v[180:183]
    buffer_load_dwordx4 v206, s[4:7], s46 offen offset:0 lds
    ds_read_b128 v[116:119], v79 offset:16384
    v_mfma_f32_16x16x32_bf16 v[200:203], v[152:155], v[144:147], v[200:203]
    s_add_u32 m0, s36, 143360
    s_nop 0
    buffer_load_dwordx4 v206, s[4:7], s47 offen offset:0 lds
    s_add_u32 m0, s36, 147456
    s_nop 0
    buffer_load_dwordx4 v206, s[4:7], s48 offen offset:0 lds
    s_add_u32 s42, s99, 2097152
    s_and_b32 s42, s42, 3670016
    s_add_u32 s38, s42, 0
    s_add_u32 m0, s36, 81920
    s_nop 0
    buffer_load_dwordx4 v85, s[8:11], s38 offen offset:0 lds
    s_waitcnt vmcnt(10)
    s_barrier
    s_waitcnt lgkmcnt(9)
    v_mfma_f32_16x16x32_bf16 v[164:167], v[156:159], v[208:211], v[164:167]
    s_add_u32 s38, s42, 131072
    s_add_u32 m0, s36, 86016
    ds_read_b64_tr_b16 v[148:149], v82 offset:8192
    v_mfma_f32_16x16x32_bf16 v[184:187], v[160:163], v[208:211], v[184:187]
    buffer_load_dwordx4 v85, s[8:11], s38 offen offset:0 lds
    ds_read_b64_tr_b16 v[150:151], v82 offset:9216
    v_mfma_f32_16x16x32_bf16 v[168:171], v[156:159], v[212:215], v[168:171]
    s_add_u32 s38, s42, 262144
    ds_read_b128 v[128:131], v76 offset:20480
    v_mfma_f32_16x16x32_bf16 v[188:191], v[160:163], v[212:215], v[188:191]
    s_add_u32 m0, s36, 90112
    ds_read_b64_tr_b16 v[152:153], v83 offset:8192
    v_mfma_f32_16x16x32_bf16 v[172:175], v[156:159], v[216:219], v[172:175]
    buffer_load_dwordx4 v85, s[8:11], s38 offen offset:0 lds
    ds_read_b64_tr_b16 v[154:155], v83 offset:9216
    v_mfma_f32_16x16x32_bf16 v[192:195], v[160:163], v[216:219], v[192:195]
    s_add_u32 s38, s42, 393216
    ds_read_b128 v[132:135], v76 offset:24576
    v_mfma_f32_16x16x32_bf16 v[176:179], v[156:159], v[220:223], v[176:179]
    s_add_u32 m0, s36, 94208
    ds_read_b128 v[136:139], v76 offset:28672
    v_mfma_f32_16x16x32_bf16 v[196:199], v[160:163], v[220:223], v[196:199]
    buffer_load_dwordx4 v85, s[8:11], s38 offen offset:0 lds
    ds_read_b128 v[140:143], v76 offset:32768
    v_mfma_f32_16x16x32_bf16 v[180:183], v[156:159], v[224:227], v[180:183]
    ds_read_b128 v[144:147], v76 offset:36864
    v_mfma_f32_16x16x32_bf16 v[200:203], v[160:163], v[224:227], v[200:203]
    s_waitcnt lgkmcnt(9)
    v_mfma_f32_16x16x32_bf16 v[164:167], v[120:123], v[100:103], v[164:167]
    s_add_u32 s42, s99, 2097152
    s_and_b32 s42, s42, 3670016
    s_xor_b32 s42, s42, 524288
    s_add_u32 s38, s42, 0
    s_add_u32 m0, s36, 40960
    ds_read_b64_tr_b16 v[156:157], v82 offset:16384
    v_mfma_f32_16x16x32_bf16 v[184:187], v[124:127], v[100:103], v[184:187]
    buffer_load_dwordx4 v85, s[8:11], s38 offen offset:0 lds
    ds_read_b64_tr_b16 v[158:159], v82 offset:17408
    v_mfma_f32_16x16x32_bf16 v[168:171], v[120:123], v[104:107], v[168:171]
    s_add_u32 s38, s42, 131072
    ds_read_b128 v[208:211], v77 offset:20480
    v_mfma_f32_16x16x32_bf16 v[188:191], v[124:127], v[104:107], v[188:191]
    s_add_u32 m0, s36, 45056
    ds_read_b64_tr_b16 v[160:161], v83 offset:16384
    v_mfma_f32_16x16x32_bf16 v[172:175], v[120:123], v[108:111], v[172:175]
    buffer_load_dwordx4 v85, s[8:11], s38 offen offset:0 lds
    ds_read_b64_tr_b16 v[162:163], v83 offset:17408
    v_mfma_f32_16x16x32_bf16 v[192:195], v[124:127], v[108:111], v[192:195]
    ds_read_b128 v[212:215], v77 offset:24576
    v_mfma_f32_16x16x32_bf16 v[176:179], v[120:123], v[112:115], v[176:179]
    s_add_u32 s38, s42, 262144
    ds_read_b128 v[216:219], v77 offset:28672
    v_mfma_f32_16x16x32_bf16 v[196:199], v[124:127], v[112:115], v[196:199]
    s_add_u32 m0, s36, 49152
    ds_read_b128 v[220:223], v77 offset:32768
    v_mfma_f32_16x16x32_bf16 v[180:183], v[120:123], v[116:119], v[180:183]
    buffer_load_dwordx4 v85, s[8:11], s38 offen offset:0 lds
    ds_read_b128 v[224:227], v77 offset:36864
    v_mfma_f32_16x16x32_bf16 v[200:203], v[124:127], v[116:119], v[200:203]
    s_waitcnt vmcnt(12)
    s_barrier
    s_waitcnt lgkmcnt(9)
    v_mfma_f32_16x16x32_bf16 v[164:167], v[148:151], v[128:131], v[164:167]
    s_add_u32 s38, s42, 393216
    s_add_u32 m0, s36, 53248
    ds_read_b64_tr_b16 v[120:121], v80 offset:24576
    v_mfma_f32_16x16x32_bf16 v[184:187], v[152:155], v[128:131], v[184:187]
    buffer_load_dwordx4 v85, s[8:11], s38 offen offset:0 lds
    ds_read_b64_tr_b16 v[122:123], v80 offset:25600
    v_mfma_f32_16x16x32_bf16 v[168:171], v[148:151], v[132:135], v[168:171]
    ds_read_b128 v[100:103], v78 offset:20480
    v_mfma_f32_16x16x32_bf16 v[188:191], v[152:155], v[132:135], v[188:191]
    s_add_u32 m0, s36, 122880
    ds_read_b64_tr_b16 v[124:125], v81 offset:24576
    v_mfma_f32_16x16x32_bf16 v[172:175], v[148:151], v[136:139], v[172:175]
    buffer_load_dwordx4 v207, s[4:7], s44 offen offset:0 lds
    ds_read_b64_tr_b16 v[126:127], v81 offset:25600
    v_mfma_f32_16x16x32_bf16 v[192:195], v[152:155], v[136:139], v[192:195]
    ds_read_b128 v[104:107], v78 offset:24576
    v_mfma_f32_16x16x32_bf16 v[176:179], v[148:151], v[140:143], v[176:179]
    s_add_u32 m0, s36, 126976
    ds_read_b128 v[108:111], v78 offset:28672
    v_mfma_f32_16x16x32_bf16 v[196:199], v[152:155], v[140:143], v[196:199]
    buffer_load_dwordx4 v207, s[4:7], s45 offen offset:0 lds
    ds_read_b128 v[112:115], v78 offset:32768
    v_mfma_f32_16x16x32_bf16 v[180:183], v[148:151], v[144:147], v[180:183]
    ds_read_b128 v[116:119], v78 offset:36864
    v_mfma_f32_16x16x32_bf16 v[200:203], v[152:155], v[144:147], v[200:203]
    s_waitcnt lgkmcnt(9)
    v_mfma_f32_16x16x32_bf16 v[164:167], v[156:159], v[208:211], v[164:167]
    s_add_u32 m0, s36, 151552
    ds_read_b64_tr_b16 v[148:149], v80 offset:32768
    v_mfma_f32_16x16x32_bf16 v[184:187], v[160:163], v[208:211], v[184:187]
    buffer_load_dwordx4 v207, s[4:7], s46 offen offset:0 lds
    ds_read_b64_tr_b16 v[150:151], v80 offset:33792
    v_mfma_f32_16x16x32_bf16 v[168:171], v[156:159], v[212:215], v[168:171]
    ds_read_b128 v[128:131], v79 offset:20480
    v_mfma_f32_16x16x32_bf16 v[188:191], v[160:163], v[212:215], v[188:191]
    s_add_u32 m0, s36, 155648
    ds_read_b64_tr_b16 v[152:153], v81 offset:32768
    v_mfma_f32_16x16x32_bf16 v[172:175], v[156:159], v[216:219], v[172:175]
    buffer_load_dwordx4 v207, s[4:7], s47 offen offset:0 lds
    ds_read_b64_tr_b16 v[154:155], v81 offset:33792
    v_mfma_f32_16x16x32_bf16 v[192:195], v[160:163], v[216:219], v[192:195]
    ds_read_b128 v[132:135], v79 offset:24576
    v_mfma_f32_16x16x32_bf16 v[176:179], v[156:159], v[220:223], v[176:179]
    ds_read_b128 v[136:139], v79 offset:28672
    v_mfma_f32_16x16x32_bf16 v[196:199], v[160:163], v[220:223], v[196:199]
    s_add_u32 m0, s36, 159744
    ds_read_b128 v[140:143], v79 offset:32768
    v_mfma_f32_16x16x32_bf16 v[180:183], v[156:159], v[224:227], v[180:183]
    buffer_load_dwordx4 v207, s[4:7], s48 offen offset:0 lds
    ds_read_b128 v[144:147], v79 offset:36864
    v_mfma_f32_16x16x32_bf16 v[200:203], v[160:163], v[224:227], v[200:203]
    s_add_u32 s42, s99, 3145728
    s_and_b32 s42, s42, 3670016
    s_add_u32 s38, s42, 0
    s_add_u32 m0, s36, 57344
    s_nop 0
    buffer_load_dwordx4 v85, s[8:11], s38 offen offset:0 lds
    s_waitcnt vmcnt(10) lgkmcnt(0)
    s_barrier
    v_mfma_f32_16x16x32_bf16 v[164:167], v[120:123], v[100:103], v[164:167]
    s_add_u32 s38, s42, 131072
    s_add_u32 m0, s36, 61440
    ds_read_b64_tr_b16 v[156:157], v80 offset:40960
    v_mfma_f32_16x16x32_bf16 v[184:187], v[124:127], v[100:103], v[184:187]
    buffer_load_dwordx4 v85, s[8:11], s38 offen offset:0 lds
    ds_read_b64_tr_b16 v[158:159], v80 offset:41984
    v_mfma_f32_16x16x32_bf16 v[168:171], v[120:123], v[104:107], v[168:171]
    s_add_u32 s38, s42, 262144
    ds_read_b128 v[208:211], v56 offset:8192
    v_mfma_f32_16x16x32_bf16 v[188:191], v[124:127], v[104:107], v[188:191]
    s_add_u32 m0, s36, 98304
    ds_read_b64_tr_b16 v[160:161], v81 offset:40960
    v_mfma_f32_16x16x32_bf16 v[172:175], v[120:123], v[108:111], v[172:175]
    buffer_load_dwordx4 v85, s[8:11], s38 offen offset:0 lds
    ds_read_b64_tr_b16 v[162:163], v81 offset:41984
    v_mfma_f32_16x16x32_bf16 v[192:195], v[124:127], v[108:111], v[192:195]
    s_add_u32 s38, s42, 393216
    ds_read_b128 v[212:215], v56 offset:12288
    v_mfma_f32_16x16x32_bf16 v[176:179], v[120:123], v[112:115], v[176:179]
    s_add_u32 m0, s36, 102400
    ds_read_b128 v[216:219], v56 offset:16384
    v_mfma_f32_16x16x32_bf16 v[196:199], v[124:127], v[112:115], v[196:199]
    buffer_load_dwordx4 v85, s[8:11], s38 offen offset:0 lds
    ds_read_b128 v[220:223], v56 offset:20480
    v_mfma_f32_16x16x32_bf16 v[180:183], v[120:123], v[116:119], v[180:183]
    ds_read_b128 v[224:227], v56 offset:24576
    v_mfma_f32_16x16x32_bf16 v[200:203], v[124:127], v[116:119], v[200:203]
    v_mfma_f32_16x16x32_bf16 v[164:167], v[148:151], v[128:131], v[164:167]
    s_add_u32 s42, s99, 3145728
    s_and_b32 s42, s42, 3670016
    s_xor_b32 s42, s42, 524288
    s_add_u32 s38, s42, 0
    s_add_u32 m0, s36, 106496
    ds_read_b64_tr_b16 v[120:121], v80 offset:49152
    v_mfma_f32_16x16x32_bf16 v[184:187], v[152:155], v[128:131], v[184:187]
    buffer_load_dwordx4 v85, s[8:11], s38 offen offset:0 lds
    ds_read_b64_tr_b16 v[122:123], v80 offset:50176
    v_mfma_f32_16x16x32_bf16 v[168:171], v[148:151], v[132:135], v[168:171]
    s_add_u32 s38, s42, 131072
    ds_read_b128 v[100:103], v57 offset:8192
    v_mfma_f32_16x16x32_bf16 v[188:191], v[152:155], v[132:135], v[188:191]
    s_add_u32 m0, s36, 110592
    ds_read_b64_tr_b16 v[124:125], v81 offset:49152
    v_mfma_f32_16x16x32_bf16 v[172:175], v[148:151], v[136:139], v[172:175]
    buffer_load_dwordx4 v85, s[8:11], s38 offen offset:0 lds
    ds_read_b64_tr_b16 v[126:127], v81 offset:50176
    v_mfma_f32_16x16x32_bf16 v[192:195], v[152:155], v[136:139], v[192:195]
    ds_read_b128 v[104:107], v57 offset:12288
    v_mfma_f32_16x16x32_bf16 v[176:179], v[148:151], v[140:143], v[176:179]
    s_add_u32 s38, s42, 262144
    ds_read_b128 v[108:111], v57 offset:16384
    v_mfma_f32_16x16x32_bf16 v[196:199], v[152:155], v[140:143], v[196:199]
    s_add_u32 m0, s36, 114688
    ds_read_b128 v[112:115], v57 offset:20480
    v_mfma_f32_16x16x32_bf16 v[180:183], v[148:151], v[144:147], v[180:183]
    buffer_load_dwordx4 v85, s[8:11], s38 offen offset:0 lds
    ds_read_b128 v[116:119], v57 offset:24576
    v_mfma_f32_16x16x32_bf16 v[200:203], v[152:155], v[144:147], v[200:203]
    s_waitcnt vmcnt(12) lgkmcnt(0)
    s_barrier
    v_mfma_f32_16x16x32_bf16 v[164:167], v[156:159], v[208:211], v[164:167]
    s_add_u32 s38, s42, 393216
    s_add_u32 m0, s36, 118784
    ds_read_b64_tr_b16 v[148:149], v80 offset:0
    v_mfma_f32_16x16x32_bf16 v[184:187], v[160:163], v[208:211], v[184:187]
    buffer_load_dwordx4 v85, s[8:11], s38 offen offset:0 lds
    ds_read_b64_tr_b16 v[150:151], v80 offset:1024
    v_mfma_f32_16x16x32_bf16 v[168:171], v[156:159], v[212:215], v[168:171]
    s_bfe_u32 s42, s98, 0x30000
    s_lshl_b32 s42, s42, 13
    ds_read_b128 v[128:131], v58 offset:8192
    v_mfma_f32_16x16x32_bf16 v[188:191], v[160:163], v[212:215], v[188:191]
    s_add_u32 m0, s37, 0
    ds_read_b64_tr_b16 v[152:153], v81 offset:0
    v_mfma_f32_16x16x32_bf16 v[172:175], v[156:159], v[216:219], v[172:175]
    buffer_load_dwordx4 v22, s[12:15], s42 offen offset:0 lds
    ds_read_b64_tr_b16 v[154:155], v81 offset:1024
    v_mfma_f32_16x16x32_bf16 v[192:195], v[160:163], v[216:219], v[192:195]
    ds_read_b128 v[132:135], v58 offset:12288
    v_mfma_f32_16x16x32_bf16 v[176:179], v[156:159], v[220:223], v[176:179]
    ds_read_b128 v[136:139], v58 offset:16384
    v_mfma_f32_16x16x32_bf16 v[196:199], v[160:163], v[220:223], v[196:199]
    buffer_load_dwordx4 v23, s[12:15], s42 offen offset:1024 lds
    ds_read_b128 v[140:143], v58 offset:20480
    v_mfma_f32_16x16x32_bf16 v[180:183], v[156:159], v[224:227], v[180:183]
    ds_read_b128 v[144:147], v58 offset:24576
    v_mfma_f32_16x16x32_bf16 v[200:203], v[160:163], v[224:227], v[200:203]
    v_mfma_f32_16x16x32_bf16 v[164:167], v[120:123], v[100:103], v[164:167]
    ds_read_b64_tr_b16 v[156:157], v80 offset:8192
    v_mfma_f32_16x16x32_bf16 v[184:187], v[124:127], v[100:103], v[184:187]
    buffer_load_dwordx4 v24, s[12:15], s42 offen offset:2048 lds
    ds_read_b64_tr_b16 v[158:159], v80 offset:9216
    v_mfma_f32_16x16x32_bf16 v[168:171], v[120:123], v[104:107], v[168:171]
    ds_read_b128 v[208:211], v59 offset:8192
    v_mfma_f32_16x16x32_bf16 v[188:191], v[124:127], v[104:107], v[188:191]
    ds_read_b64_tr_b16 v[160:161], v81 offset:8192
    v_mfma_f32_16x16x32_bf16 v[172:175], v[120:123], v[108:111], v[172:175]
    buffer_load_dwordx4 v25, s[12:15], s42 offen offset:3072 lds
    ds_read_b64_tr_b16 v[162:163], v81 offset:9216
    v_mfma_f32_16x16x32_bf16 v[192:195], v[124:127], v[108:111], v[192:195]
    ds_read_b128 v[212:215], v59 offset:12288
    v_mfma_f32_16x16x32_bf16 v[176:179], v[120:123], v[112:115], v[176:179]
    s_add_u32 s42, s42, 4096
    ds_read_b128 v[216:219], v59 offset:16384
    v_mfma_f32_16x16x32_bf16 v[196:199], v[124:127], v[112:115], v[196:199]
    s_add_u32 m0, s37, 4096
    ds_read_b128 v[220:223], v59 offset:20480
    v_mfma_f32_16x16x32_bf16 v[180:183], v[120:123], v[116:119], v[180:183]
    buffer_load_dwordx4 v22, s[12:15], s42 offen offset:0 lds
    ds_read_b128 v[224:227], v59 offset:24576
    v_mfma_f32_16x16x32_bf16 v[200:203], v[124:127], v[116:119], v[200:203]
    buffer_load_dwordx4 v23, s[12:15], s42 offen offset:1024 lds
    s_waitcnt vmcnt(10)
    s_barrier
    s_waitcnt lgkmcnt(9)
    v_mfma_f32_16x16x32_bf16 v[164:167], v[148:151], v[128:131], v[164:167]
    ds_read_b64_tr_b16 v[120:121], v80 offset:16384
    v_mfma_f32_16x16x32_bf16 v[184:187], v[152:155], v[128:131], v[184:187]
    buffer_load_dwordx4 v24, s[12:15], s42 offen offset:2048 lds
    ds_read_b64_tr_b16 v[122:123], v80 offset:17408
    v_mfma_f32_16x16x32_bf16 v[168:171], v[148:151], v[132:135], v[168:171]
    ds_read_b128 v[100:103], v56 offset:0
    v_mfma_f32_16x16x32_bf16 v[188:191], v[152:155], v[132:135], v[188:191]
    ds_read_b64_tr_b16 v[124:125], v81 offset:16384
    v_mfma_f32_16x16x32_bf16 v[172:175], v[148:151], v[136:139], v[172:175]
    buffer_load_dwordx4 v25, s[12:15], s42 offen offset:3072 lds
    ds_read_b64_tr_b16 v[126:127], v81 offset:17408
    v_mfma_f32_16x16x32_bf16 v[192:195], v[152:155], v[136:139], v[192:195]
    s_bfe_u32 s43, s98, 0x30000
    s_lshl_b32 s43, s43, 13
    ds_read_b128 v[104:107], v56 offset:4096
    v_mfma_f32_16x16x32_bf16 v[176:179], v[148:151], v[140:143], v[176:179]
    s_add_u32 m0, s37, 65536
    ds_read_b128 v[108:111], v56 offset:28672
    v_mfma_f32_16x16x32_bf16 v[196:199], v[152:155], v[140:143], v[196:199]
    buffer_load_dwordx4 v26, s[16:19], s43 offen offset:0 lds
    ds_read_b128 v[112:115], v56 offset:32768
    v_mfma_f32_16x16x32_bf16 v[180:183], v[148:151], v[144:147], v[180:183]
    ds_read_b128 v[116:119], v56 offset:36864
    v_mfma_f32_16x16x32_bf16 v[200:203], v[152:155], v[144:147], v[200:203]
    s_waitcnt lgkmcnt(9)
    v_mfma_f32_16x16x32_bf16 v[164:167], v[156:159], v[208:211], v[164:167]
    ds_read_b64_tr_b16 v[148:149], v82 offset:0
    v_mfma_f32_16x16x32_bf16 v[184:187], v[160:163], v[208:211], v[184:187]
    buffer_load_dwordx4 v27, s[16:19], s43 offen offset:1024 lds
    ds_read_b64_tr_b16 v[150:151], v82 offset:1024
    v_mfma_f32_16x16x32_bf16 v[168:171], v[156:159], v[212:215], v[168:171]
    ds_read_b128 v[128:131], v57 offset:0
    v_mfma_f32_16x16x32_bf16 v[188:191], v[160:163], v[212:215], v[188:191]
    ds_read_b64_tr_b16 v[152:153], v83 offset:0
    v_mfma_f32_16x16x32_bf16 v[172:175], v[156:159], v[216:219], v[172:175]
    buffer_load_dwordx4 v26, s[16:19], s43 offen offset:2048 lds
    ds_read_b64_tr_b16 v[154:155], v83 offset:1024
    v_mfma_f32_16x16x32_bf16 v[192:195], v[160:163], v[216:219], v[192:195]
    ds_read_b128 v[132:135], v57 offset:4096
    v_mfma_f32_16x16x32_bf16 v[176:179], v[156:159], v[220:223], v[176:179]
    ds_read_b128 v[136:139], v57 offset:28672
    v_mfma_f32_16x16x32_bf16 v[196:199], v[160:163], v[220:223], v[196:199]
    ds_read_b128 v[140:143], v57 offset:32768
    v_mfma_f32_16x16x32_bf16 v[180:183], v[156:159], v[224:227], v[180:183]
    buffer_load_dwordx4 v27, s[16:19], s43 offen offset:3072 lds
    ds_read_b128 v[144:147], v57 offset:36864
    v_mfma_f32_16x16x32_bf16 v[200:203], v[160:163], v[224:227], v[200:203]
    s_waitcnt vmcnt(12)
    s_barrier
    s_waitcnt lgkmcnt(9)
    v_mfma_f32_16x16x32_bf16 v[164:167], v[120:123], v[100:103], v[164:167]
    s_add_u32 s43, s43, 4096
    s_add_u32 m0, s37, 69632
    ds_read_b64_tr_b16 v[156:157], v82 offset:8192
    v_mfma_f32_16x16x32_bf16 v[184:187], v[124:127], v[100:103], v[184:187]
    buffer_load_dwordx4 v26, s[16:19], s43 offen offset:0 lds
    ds_read_b64_tr_b16 v[158:159], v82 offset:9216
    v_mfma_f32_16x16x32_bf16 v[168:171], v[120:123], v[104:107], v[168:171]
    ds_read_b128 v[208:211], v58 offset:0
    v_mfma_f32_16x16x32_bf16 v[188:191], v[124:127], v[104:107], v[188:191]
    ds_read_b64_tr_b16 v[160:161], v83 offset:8192
    v_mfma_f32_16x16x32_bf16 v[172:175], v[120:123], v[108:111], v[172:175]
    buffer_load_dwordx4 v27, s[16:19], s43 offen offset:1024 lds
    ds_read_b64_tr_b16 v[162:163], v83 offset:9216
    v_mfma_f32_16x16x32_bf16 v[192:195], v[124:127], v[108:111], v[192:195]
    ds_read_b128 v[212:215], v58 offset:4096
    v_mfma_f32_16x16x32_bf16 v[176:179], v[120:123], v[112:115], v[176:179]
    ds_read_b128 v[216:219], v58 offset:28672
    v_mfma_f32_16x16x32_bf16 v[196:199], v[124:127], v[112:115], v[196:199]
    buffer_load_dwordx4 v26, s[16:19], s43 offen offset:2048 lds
    ds_read_b128 v[220:223], v58 offset:32768
    v_mfma_f32_16x16x32_bf16 v[180:183], v[120:123], v[116:119], v[180:183]
    ds_read_b128 v[224:227], v58 offset:36864
    v_mfma_f32_16x16x32_bf16 v[200:203], v[124:127], v[116:119], v[200:203]
    s_waitcnt lgkmcnt(9)
    v_mfma_f32_16x16x32_bf16 v[164:167], v[148:151], v[128:131], v[164:167]
    ds_read_b64_tr_b16 v[120:121], v82 offset:16384
    v_mfma_f32_16x16x32_bf16 v[184:187], v[152:155], v[128:131], v[184:187]
    buffer_load_dwordx4 v27, s[16:19], s43 offen offset:3072 lds
    ds_read_b64_tr_b16 v[122:123], v82 offset:17408
    v_mfma_f32_16x16x32_bf16 v[168:171], v[148:151], v[132:135], v[168:171]
    ds_read_b128 v[100:103], v59 offset:0
    v_mfma_f32_16x16x32_bf16 v[188:191], v[152:155], v[132:135], v[188:191]
    ds_read_b64_tr_b16 v[124:125], v83 offset:16384
    v_mfma_f32_16x16x32_bf16 v[172:175], v[148:151], v[136:139], v[172:175]
    ds_read_b64_tr_b16 v[126:127], v83 offset:17408
    v_mfma_f32_16x16x32_bf16 v[192:195], v[152:155], v[136:139], v[192:195]
    ds_read_b128 v[104:107], v59 offset:4096
    v_mfma_f32_16x16x32_bf16 v[176:179], v[148:151], v[140:143], v[176:179]
    ds_read_b128 v[108:111], v59 offset:28672
    v_mfma_f32_16x16x32_bf16 v[196:199], v[152:155], v[140:143], v[196:199]
    ds_read_b128 v[112:115], v59 offset:32768
    v_mfma_f32_16x16x32_bf16 v[180:183], v[148:151], v[144:147], v[180:183]
    ds_read_b128 v[116:119], v59 offset:36864
    v_mfma_f32_16x16x32_bf16 v[200:203], v[152:155], v[144:147], v[200:203]
    s_waitcnt lgkmcnt(9)
    v_mfma_f32_16x16x32_bf16 v[164:167], v[156:159], v[208:211], v[164:167]
    s_waitcnt lgkmcnt(6)
    v_mfma_f32_16x16x32_bf16 v[164:167], v[120:123], v[100:103], v[164:167]
    v_mfma_f32_16x16x32_bf16 v[184:187], v[160:163], v[208:211], v[184:187]
    s_waitcnt lgkmcnt(4)
    v_mfma_f32_16x16x32_bf16 v[184:187], v[124:127], v[100:103], v[184:187]
    v_mfma_f32_16x16x32_bf16 v[168:171], v[156:159], v[212:215], v[168:171]
    s_waitcnt lgkmcnt(3)
    v_mfma_f32_16x16x32_bf16 v[168:171], v[120:123], v[104:107], v[168:171]
    s_nop 1
    v_mul_f32 v164, s40, v164
    v_mul_f32 v165, s40, v165
    v_mfma_f32_16x16x32_bf16 v[188:191], v[160:163], v[212:215], v[188:191]
    v_mul_f32 v166, s40, v166
    v_mul_f32 v167, s40, v167
    v_mfma_f32_16x16x32_bf16 v[188:191], v[124:127], v[104:107], v[188:191]
    v_cvt_pk_bf16_f32 v164, v164, v165
    v_cvt_pk_bf16_f32 v165, v166, v167
    v_mfma_f32_16x16x32_bf16 v[172:175], v[156:159], v[216:219], v[172:175]
    s_waitcnt lgkmcnt(2)
    ds_write_b64 v86, v[164:165] offset:0
    v_mul_f32 v184, s40, v184
    v_mul_f32 v185, s40, v185
    v_mfma_f32_16x16x32_bf16 v[172:175], v[120:123], v[108:111], v[172:175]
    v_mul_f32 v186, s40, v186
    v_mul_f32 v187, s40, v187
    v_mfma_f32_16x16x32_bf16 v[192:195], v[160:163], v[216:219], v[192:195]
    v_cvt_pk_bf16_f32 v184, v184, v185
    v_cvt_pk_bf16_f32 v185, v186, v187
    v_mfma_f32_16x16x32_bf16 v[192:195], v[124:127], v[108:111], v[192:195]
    ds_write_b64 v87, v[184:185] offset:0
    v_mul_f32 v168, s40, v168
    v_mul_f32 v169, s40, v169
    v_mfma_f32_16x16x32_bf16 v[176:179], v[156:159], v[220:223], v[176:179]
    s_waitcnt lgkmcnt(3)
    v_mul_f32 v170, s40, v170
    v_mul_f32 v171, s40, v171
    v_mfma_f32_16x16x32_bf16 v[176:179], v[120:123], v[112:115], v[176:179]
    v_cvt_pk_bf16_f32 v168, v168, v169
    v_cvt_pk_bf16_f32 v169, v170, v171
    v_mfma_f32_16x16x32_bf16 v[196:199], v[160:163], v[220:223], v[196:199]
    ds_write_b64 v86, v[168:169] offset:4096
    v_mul_f32 v188, s40, v188
    v_mul_f32 v189, s40, v189
    v_mfma_f32_16x16x32_bf16 v[196:199], v[124:127], v[112:115], v[196:199]
    v_mul_f32 v190, s40, v190
    v_mul_f32 v191, s40, v191
    v_mfma_f32_16x16x32_bf16 v[180:183], v[156:159], v[224:227], v[180:183]
    s_waitcnt lgkmcnt(3)
    v_cvt_pk_bf16_f32 v188, v188, v189
    v_cvt_pk_bf16_f32 v189, v190, v191
    v_mfma_f32_16x16x32_bf16 v[180:183], v[120:123], v[116:119], v[180:183]
    ds_write_b64 v87, v[188:189] offset:4096
    v_mfma_f32_16x16x32_bf16 v[200:203], v[160:163], v[224:227], v[200:203]
    v_mfma_f32_16x16x32_bf16 v[200:203], v[124:127], v[116:119], v[200:203]
    s_waitcnt vmcnt(12)
    v_pk_mul_f32 v[172:173], v[172:173], s[40:41]
    v_pk_mul_f32 v[174:175], v[174:175], s[40:41]
    v_cvt_pk_bf16_f32 v172, v172, v173
    v_cvt_pk_bf16_f32 v173, v174, v175
    ds_write_b64 v86, v[172:173] offset:8192
    v_pk_mul_f32 v[192:193], v[192:193], s[40:41]
    v_pk_mul_f32 v[194:195], v[194:195], s[40:41]
    v_cvt_pk_bf16_f32 v192, v192, v193
    v_cvt_pk_bf16_f32 v193, v194, v195
    ds_write_b64 v87, v[192:193] offset:8192
    v_pk_mul_f32 v[176:177], v[176:177], s[40:41]
    v_pk_mul_f32 v[178:179], v[178:179], s[40:41]
    v_cvt_pk_bf16_f32 v176, v176, v177
    v_cvt_pk_bf16_f32 v177, v178, v179
    ds_write_b64 v86, v[176:177] offset:12288
    v_pk_mul_f32 v[196:197], v[196:197], s[40:41]
    v_pk_mul_f32 v[198:199], v[198:199], s[40:41]
    v_cvt_pk_bf16_f32 v196, v196, v197
    v_cvt_pk_bf16_f32 v197, v198, v199
    ds_write_b64 v87, v[196:197] offset:12288
    v_pk_mul_f32 v[180:181], v[180:181], s[40:41]
    v_pk_mul_f32 v[182:183], v[182:183], s[40:41]
    v_cvt_pk_bf16_f32 v180, v180, v181
    v_cvt_pk_bf16_f32 v181, v182, v183
    ds_write_b64 v86, v[180:181] offset:16384
    v_pk_mul_f32 v[200:201], v[200:201], s[40:41]
    v_pk_mul_f32 v[202:203], v[202:203], s[40:41]
    v_cvt_pk_bf16_f32 v200, v200, v201
    v_cvt_pk_bf16_f32 v201, v202, v203
    ds_write_b64 v87, v[200:201] offset:16384
    ds_read_b128 v[100:103], v10 offset:0
    ds_read_b128 v[104:107], v11 offset:0
    ds_read_b128 v[108:111], v12 offset:0
    ds_read_b128 v[112:115], v13 offset:0
    s_waitcnt vmcnt(8)
    ds_read_b128 v[116:119], v10 offset:4096
    ds_read_b128 v[120:123], v11 offset:4096
    ds_read_b128 v[124:127], v12 offset:4096
    ds_read_b128 v[128:131], v13 offset:4096
    s_waitcnt lgkmcnt(8)
    s_barrier
    s_cmp_eq_u32 s68, 0
    s_cbranch_scc1 L_back_max
    ds_read_b128 a[160:163], v56 offset:8192
    ds_read_b128 a[164:167], v57 offset:8192
    ds_read_b128 a[168:171], v58 offset:8192
    ds_read_b128 a[172:175], v59 offset:8192
    ds_read_b128 a[176:179], v56 offset:12288
    ds_read_b128 a[180:183], v57 offset:12288
    ds_read_b128 a[184:187], v58 offset:12288
    ds_read_b128 a[188:191], v59 offset:12288
    ds_read_b128 a[192:195], v56 offset:16384
    ds_read_b128 a[196:199], v57 offset:16384
    ds_read_b128 a[200:203], v58 offset:16384
    ds_read_b128 a[204:207], v59 offset:16384
    ds_read_b128 a[208:211], v56 offset:20480
    ds_read_b128 a[212:215], v57 offset:20480
    ds_read_b128 a[216:219], v58 offset:20480
    ds_read_b128 a[220:223], v59 offset:20480
    ds_read_b128 a[224:227], v56 offset:24576
    ds_read_b128 a[228:231], v57 offset:24576
    ds_read_b128 a[232:235], v58 offset:24576
    ds_read_b128 a[236:239], v59 offset:24576
    s_branch L_max
L_back_max:
    ds_read_b128 a[160:163], v56 offset:8192
    ds_read_b128 a[164:167], v57 offset:8192
    ds_read_b128 a[168:171], v58 offset:8192
    ds_read_b128 a[172:175], v59 offset:8192
    s_waitcnt lgkmcnt(3)
    v_mfma_f32_16x16x32_bf16 v[76:79], v[100:103], a[160:163], v[36:39]
    s_bfe_u32 s42, s98, 0x30004
    s_lshl_b32 s42, s42, 13
    s_add_u32 m0, s37, 32768
    ds_read_b128 a[176:179], v56 offset:12288
    ds_read_b128 a[180:183], v57 offset:12288
    s_waitcnt lgkmcnt(4)
    v_mfma_f32_16x16x32_bf16 v[76:79], v[104:107], a[164:167], v[76:79]
    s_waitcnt lgkmcnt(3)
    buffer_load_dwordx4 v22, s[12:15], s42 offen offset:0 lds
    ds_read_b128 a[184:187], v58 offset:12288
    ds_read_b128 a[188:191], v59 offset:12288
    v_mfma_f32_16x16x32_bf16 v[76:79], v[108:111], a[168:171], v[76:79]
    s_waitcnt lgkmcnt(4)
    ds_read_b128 a[192:195], v56 offset:16384
    ds_read_b128 a[196:199], v57 offset:16384
    v_mfma_f32_16x16x32_bf16 v[76:79], v[112:115], a[172:175], v[76:79]
    buffer_load_dwordx4 v23, s[12:15], s42 offen offset:1024 lds
    ds_read_b128 a[200:203], v58 offset:16384
    ds_read_b128 a[204:207], v59 offset:16384
    v_mfma_f32_16x16x32_bf16 v[80:83], v[116:119], a[160:163], v[36:39]
    ds_read_b128 a[208:211], v56 offset:20480
    ds_read_b128 a[212:215], v57 offset:20480
    v_mfma_f32_16x16x32_bf16 v[80:83], v[120:123], a[164:167], v[80:83]
    buffer_load_dwordx4 v24, s[12:15], s42 offen offset:2048 lds
    ds_read_b128 a[216:219], v58 offset:20480
    ds_read_b128 a[220:223], v59 offset:20480
    v_mfma_f32_16x16x32_bf16 v[80:83], v[124:127], a[168:171], v[80:83]
    ds_read_b128 a[224:227], v56 offset:24576
    ds_read_b128 a[228:231], v57 offset:24576
    v_mfma_f32_16x16x32_bf16 v[80:83], v[128:131], a[172:175], v[80:83]
    s_waitcnt lgkmcnt(13)
    buffer_load_dwordx4 v25, s[12:15], s42 offen offset:3072 lds
    ds_read_b128 a[232:235], v58 offset:24576
    ds_read_b128 a[236:239], v59 offset:24576
    v_mfma_f32_16x16x32_bf16 v[84:87], v[100:103], a[176:179], v[40:43]
    s_add_u32 s42, s42, 4096
    s_add_u32 m0, s37, 36864
    s_waitcnt vmcnt(8)
    ds_read_b64_tr_b16 v[164:165], v14 offset:0
    ds_read_b64_tr_b16 v[168:169], v15 offset:0
    v_exp_f32 v76, v76
    s_waitcnt lgkmcnt(15)
    v_mfma_f32_16x16x32_bf16 v[84:87], v[104:107], a[180:183], v[84:87]
    buffer_load_dwordx4 v22, s[12:15], s42 offen offset:0 lds
    ds_read_b64_tr_b16 v[172:173], v16 offset:0
    ds_read_b64_tr_b16 v[176:177], v17 offset:0
    v_exp_f32 v77, v77
    v_mfma_f32_16x16x32_bf16 v[84:87], v[108:111], a[184:187], v[84:87]
    s_waitcnt lgkmcnt(13)
    ds_read_b64_tr_b16 v[180:181], v18 offset:0
    ds_read_b64_tr_b16 v[184:185], v19 offset:0
    v_exp_f32 v78, v78
    v_cvt_pk_bf16_f32 v92, v76, v77
    v_mfma_f32_16x16x32_bf16 v[84:87], v[112:115], a[188:191], v[84:87]
    buffer_load_dwordx4 v23, s[12:15], s42 offen offset:1024 lds
    ds_read_b64_tr_b16 v[188:189], v20 offset:0
    ds_read_b64_tr_b16 v[192:193], v21 offset:0
    v_exp_f32 v79, v79
    v_mfma_f32_16x16x32_bf16 v[88:91], v[116:119], a[176:179], v[40:43]
    s_waitcnt vmcnt(6)
    ds_read_b64_tr_b16 v[166:167], v14 offset:4096
    ds_read_b64_tr_b16 v[170:171], v15 offset:4096
    v_exp_f32 v80, v80
    v_cvt_pk_bf16_f32 v93, v78, v79
    v_mfma_f32_16x16x32_bf16 v[88:91], v[120:123], a[180:183], v[88:91]
    buffer_load_dwordx4 v24, s[12:15], s42 offen offset:2048 lds
    ds_read_b64_tr_b16 v[174:175], v16 offset:4096
    ds_read_b64_tr_b16 v[178:179], v17 offset:4096
    v_exp_f32 v81, v81
    v_mfma_f32_16x16x32_bf16 v[88:91], v[124:127], a[184:187], v[88:91]
    ds_read_b64_tr_b16 v[182:183], v18 offset:4096
    ds_read_b64_tr_b16 v[186:187], v19 offset:4096
    v_exp_f32 v82, v82
    v_cvt_pk_bf16_f32 v94, v80, v81
    v_mfma_f32_16x16x32_bf16 v[88:91], v[128:131], a[188:191], v[88:91]
    buffer_load_dwordx4 v25, s[12:15], s42 offen offset:3072 lds
    ds_read_b64_tr_b16 v[190:191], v20 offset:4096
    ds_read_b64_tr_b16 v[194:195], v21 offset:4096
    v_exp_f32 v83, v83
    s_nop 0
    v_cvt_pk_bf16_f32 v95, v82, v83
    v_mfma_f32_16x16x32_bf16 v[76:79], v[100:103], a[192:195], v[44:47]
    v_exp_f32 v84, v84
    v_mfma_f32_16x16x32_bf16 v[76:79], v[104:107], a[196:199], v[76:79]
    s_waitcnt lgkmcnt(15)
    v_mfma_f32_16x16x32_bf16 v[76:79], v[108:111], a[200:203], v[76:79]
    s_bfe_u32 s43, s98, 0x30004
    v_exp_f32 v85, v85
    v_mfma_f32_16x16x32_bf16 v[76:79], v[112:115], a[204:207], v[76:79]
    s_lshl_b32 s43, s43, 13
    v_cvt_pk_bf16_f32 v96, v84, v85
    v_mfma_f32_16x16x32_bf16 v[80:83], v[116:119], a[192:195], v[44:47]
    s_add_u32 m0, s37, 98304
    v_exp_f32 v86, v86
    v_mfma_f32_16x16x32_bf16 v[80:83], v[120:123], a[196:199], v[80:83]
    buffer_load_dwordx4 v26, s[16:19], s43 offen offset:0 lds
    v_mfma_f32_16x16x32_bf16 v[80:83], v[124:127], a[200:203], v[80:83]
    v_exp_f32 v87, v87
    v_mfma_f32_16x16x32_bf16 v[80:83], v[128:131], a[204:207], v[80:83]
    v_cvt_pk_bf16_f32 v97, v86, v87
    v_mfma_f32_16x16x32_bf16 a[240:243], v[32:35], v[92:95], 0
    s_waitcnt lgkmcnt(7)
    v_exp_f32 v88, v88
    v_mfma_f32_16x16x32_bf16 v[132:135], v[164:167], v[92:95], 0
    s_waitcnt lgkmcnt(6)
    buffer_load_dwordx4 v27, s[16:19], s43 offen offset:1024 lds
    v_mfma_f32_16x16x32_bf16 v[136:139], v[168:171], v[92:95], 0
    s_waitcnt lgkmcnt(5)
    v_exp_f32 v89, v89
    v_mfma_f32_16x16x32_bf16 a[0:3], v[172:175], v[92:95], 0
    s_waitcnt lgkmcnt(4)
    v_cvt_pk_bf16_f32 v98, v88, v89
    v_mfma_f32_16x16x32_bf16 a[4:7], v[176:179], v[92:95], 0
    s_waitcnt lgkmcnt(3)
    v_exp_f32 v90, v90
    v_mfma_f32_16x16x32_bf16 a[8:11], v[180:183], v[92:95], 0
    s_waitcnt lgkmcnt(2)
    buffer_load_dwordx4 v26, s[16:19], s43 offen offset:2048 lds
    v_mfma_f32_16x16x32_bf16 a[12:15], v[184:187], v[92:95], 0
    s_waitcnt lgkmcnt(1)
    v_exp_f32 v91, v91
    v_mfma_f32_16x16x32_bf16 a[16:19], v[188:191], v[92:95], 0
    s_waitcnt lgkmcnt(0)
    v_cvt_pk_bf16_f32 v99, v90, v91
    v_mfma_f32_16x16x32_bf16 a[20:23], v[192:195], v[92:95], 0
    buffer_load_dwordx4 v27, s[16:19], s43 offen offset:3072 lds
    v_mfma_f32_16x16x32_bf16 v[84:87], v[100:103], a[208:211], v[48:51]
    s_add_u32 s43, s43, 4096
    s_add_u32 m0, s37, 102400
    v_exp_f32 v76, v76
    v_mfma_f32_16x16x32_bf16 v[84:87], v[104:107], a[212:215], v[84:87]
    buffer_load_dwordx4 v26, s[16:19], s43 offen offset:0 lds
    v_mfma_f32_16x16x32_bf16 v[84:87], v[108:111], a[216:219], v[84:87]
    v_exp_f32 v77, v77
    v_mfma_f32_16x16x32_bf16 v[84:87], v[112:115], a[220:223], v[84:87]
    s_waitcnt vmcnt(9)
    ds_read_b128 a[120:123], v10 offset:32768
    v_cvt_pk_bf16_f32 v92, v76, v77
    v_mfma_f32_16x16x32_bf16 v[88:91], v[116:119], a[208:211], v[48:51]
    v_exp_f32 v78, v78
    v_mfma_f32_16x16x32_bf16 v[88:91], v[120:123], a[212:215], v[88:91]
    buffer_load_dwordx4 v27, s[16:19], s43 offen offset:1024 lds
    v_mfma_f32_16x16x32_bf16 v[88:91], v[124:127], a[216:219], v[88:91]
    v_exp_f32 v79, v79
    v_mfma_f32_16x16x32_bf16 v[88:91], v[128:131], a[220:223], v[88:91]
    ds_read_b128 a[124:127], v11 offset:32768
    v_cvt_pk_bf16_f32 v93, v78, v79
    v_mfma_f32_16x16x32_bf16 a[244:247], v[32:35], v[96:99], 0
    v_exp_f32 v80, v80
    v_mfma_f32_16x16x32_bf16 v[140:143], v[164:167], v[96:99], 0
    buffer_load_dwordx4 v26, s[16:19], s43 offen offset:2048 lds
    v_mfma_f32_16x16x32_bf16 v[144:147], v[168:171], v[96:99], 0
    v_exp_f32 v81, v81
    v_mfma_f32_16x16x32_bf16 a[24:27], v[172:175], v[96:99], 0
    ds_read_b128 a[128:131], v12 offset:32768
    v_cvt_pk_bf16_f32 v94, v80, v81
    v_mfma_f32_16x16x32_bf16 a[28:31], v[176:179], v[96:99], 0
    v_exp_f32 v82, v82
    v_mfma_f32_16x16x32_bf16 a[32:35], v[180:183], v[96:99], 0
    buffer_load_dwordx4 v27, s[16:19], s43 offen offset:3072 lds
    v_mfma_f32_16x16x32_bf16 a[36:39], v[184:187], v[96:99], 0
    v_exp_f32 v83, v83
    v_mfma_f32_16x16x32_bf16 a[40:43], v[188:191], v[96:99], 0
    ds_read_b128 a[132:135], v13 offset:32768
    v_cvt_pk_bf16_f32 v95, v82, v83
    v_mfma_f32_16x16x32_bf16 a[44:47], v[192:195], v[96:99], 0
    v_mfma_f32_16x16x32_bf16 v[76:79], v[100:103], a[224:227], v[52:55]
    v_exp_f32 v84, v84
    v_mfma_f32_16x16x32_bf16 v[76:79], v[104:107], a[228:231], v[76:79]
    s_waitcnt vmcnt(8)
    ds_read_b128 a[136:139], v10 offset:36864
    v_mfma_f32_16x16x32_bf16 v[76:79], v[108:111], a[232:235], v[76:79]
    s_bfe_u32 s42, s98, 0x30008
    v_exp_f32 v85, v85
    v_mfma_f32_16x16x32_bf16 v[76:79], v[112:115], a[236:239], v[76:79]
    s_lshl_b32 s42, s42, 13
    ds_read_b128 a[140:143], v11 offset:36864
    v_cvt_pk_bf16_f32 v96, v84, v85
    v_mfma_f32_16x16x32_bf16 v[80:83], v[116:119], a[224:227], v[52:55]
    s_add_u32 m0, s37, 0
    v_exp_f32 v86, v86
    v_mfma_f32_16x16x32_bf16 v[80:83], v[120:123], a[228:231], v[80:83]
    buffer_load_dwordx4 v22, s[12:15], s42 offen offset:0 lds
    v_mfma_f32_16x16x32_bf16 v[80:83], v[124:127], a[232:235], v[80:83]
    v_exp_f32 v87, v87
    v_mfma_f32_16x16x32_bf16 v[80:83], v[128:131], a[236:239], v[80:83]
    ds_read_b128 a[144:147], v12 offset:36864
    v_cvt_pk_bf16_f32 v97, v86, v87
    v_mfma_f32_16x16x32_bf16 a[248:251], v[32:35], v[92:95], 0
    v_exp_f32 v88, v88
    v_mfma_f32_16x16x32_bf16 v[148:151], v[164:167], v[92:95], 0
    buffer_load_dwordx4 v23, s[12:15], s42 offen offset:1024 lds
    v_mfma_f32_16x16x32_bf16 v[152:155], v[168:171], v[92:95], 0
    v_exp_f32 v89, v89
    v_mfma_f32_16x16x32_bf16 a[48:51], v[172:175], v[92:95], 0
    ds_read_b128 a[148:151], v13 offset:36864
    v_cvt_pk_bf16_f32 v98, v88, v89
    v_mfma_f32_16x16x32_bf16 a[52:55], v[176:179], v[92:95], 0
    v_exp_f32 v90, v90
    v_mfma_f32_16x16x32_bf16 a[56:59], v[180:183], v[92:95], 0
    buffer_load_dwordx4 v24, s[12:15], s42 offen offset:2048 lds
    v_mfma_f32_16x16x32_bf16 a[60:63], v[184:187], v[92:95], 0
    v_exp_f32 v91, v91
    v_mfma_f32_16x16x32_bf16 a[64:67], v[188:191], v[92:95], 0
    s_waitcnt vmcnt(7)
    ds_read_b64_tr_b16 v[196:197], v14 offset:32768
    v_cvt_pk_bf16_f32 v99, v90, v91
    v_mfma_f32_16x16x32_bf16 a[68:71], v[192:195], v[92:95], 0
    s_waitcnt lgkmcnt(5)
    buffer_load_dwordx4 v25, s[12:15], s42 offen offset:3072 lds
    ds_read_b64_tr_b16 v[200:201], v15 offset:32768
    v_mfma_f32_16x16x32_bf16 v[84:87], a[120:123], a[160:163], v[36:39]
    s_add_u32 s42, s42, 4096
    s_add_u32 m0, s37, 4096
    v_exp_f32 v76, v76
    v_mfma_f32_16x16x32_bf16 v[84:87], a[124:127], a[164:167], v[84:87]
    buffer_load_dwordx4 v22, s[12:15], s42 offen offset:0 lds
    v_mfma_f32_16x16x32_bf16 v[84:87], a[128:131], a[168:171], v[84:87]
    v_exp_f32 v77, v77
    v_mfma_f32_16x16x32_bf16 v[84:87], a[132:135], a[172:175], v[84:87]
    s_waitcnt lgkmcnt(2)
    ds_read_b64_tr_b16 v[204:205], v16 offset:32768
    v_cvt_pk_bf16_f32 v92, v76, v77
    v_mfma_f32_16x16x32_bf16 v[88:91], a[136:139], a[160:163], v[36:39]
    v_exp_f32 v78, v78
    v_mfma_f32_16x16x32_bf16 v[88:91], a[140:143], a[164:167], v[88:91]
    buffer_load_dwordx4 v23, s[12:15], s42 offen offset:1024 lds
    v_mfma_f32_16x16x32_bf16 v[88:91], a[144:147], a[168:171], v[88:91]
    v_exp_f32 v79, v79
    v_mfma_f32_16x16x32_bf16 v[88:91], a[148:151], a[172:175], v[88:91]
    ds_read_b64_tr_b16 v[208:209], v17 offset:32768
    v_cvt_pk_bf16_f32 v93, v78, v79
    v_mfma_f32_16x16x32_bf16 a[252:255], v[32:35], v[96:99], 0
    v_exp_f32 v80, v80
    v_mfma_f32_16x16x32_bf16 v[156:159], v[164:167], v[96:99], 0
    buffer_load_dwordx4 v24, s[12:15], s42 offen offset:2048 lds
    v_mfma_f32_16x16x32_bf16 v[160:163], v[168:171], v[96:99], 0
    v_exp_f32 v81, v81
    v_mfma_f32_16x16x32_bf16 a[72:75], v[172:175], v[96:99], 0
    ds_read_b64_tr_b16 v[212:213], v18 offset:32768
    v_cvt_pk_bf16_f32 v94, v80, v81
    v_mfma_f32_16x16x32_bf16 a[76:79], v[176:179], v[96:99], 0
    v_exp_f32 v82, v82
    v_mfma_f32_16x16x32_bf16 a[80:83], v[180:183], v[96:99], 0
    buffer_load_dwordx4 v25, s[12:15], s42 offen offset:3072 lds
    v_mfma_f32_16x16x32_bf16 a[84:87], v[184:187], v[96:99], 0
    v_exp_f32 v83, v83
    v_mfma_f32_16x16x32_bf16 a[88:91], v[188:191], v[96:99], 0
    ds_read_b64_tr_b16 v[216:217], v19 offset:32768
    v_cvt_pk_bf16_f32 v95, v82, v83
    v_mfma_f32_16x16x32_bf16 a[92:95], v[192:195], v[96:99], 0
    ds_read_b64_tr_b16 v[220:221], v20 offset:32768
    ds_read_b64_tr_b16 v[224:225], v21 offset:32768
    v_mfma_f32_16x16x32_bf16 v[76:79], a[120:123], a[176:179], v[40:43]
    s_bfe_u32 s43, s98, 0x30008
    s_lshl_b32 s43, s43, 13
    s_add_u32 m0, s37, 65536
    v_exp_f32 v84, v84
    v_mfma_f32_16x16x32_bf16 v[76:79], a[124:127], a[180:183], v[76:79]
    buffer_load_dwordx4 v26, s[16:19], s43 offen offset:0 lds
    v_mfma_f32_16x16x32_bf16 v[76:79], a[128:131], a[184:187], v[76:79]
    v_exp_f32 v85, v85
    v_mfma_f32_16x16x32_bf16 v[76:79], a[132:135], a[188:191], v[76:79]
    s_waitcnt vmcnt(9)
    ds_read_b64_tr_b16 v[198:199], v14 offset:36864
    v_cvt_pk_bf16_f32 v96, v84, v85
    v_mfma_f32_16x16x32_bf16 v[80:83], a[136:139], a[176:179], v[40:43]
    v_exp_f32 v86, v86
    v_mfma_f32_16x16x32_bf16 v[80:83], a[140:143], a[180:183], v[80:83]
    buffer_load_dwordx4 v27, s[16:19], s43 offen offset:1024 lds
    v_mfma_f32_16x16x32_bf16 v[80:83], a[144:147], a[184:187], v[80:83]
    v_exp_f32 v87, v87
    v_mfma_f32_16x16x32_bf16 v[80:83], a[148:151], a[188:191], v[80:83]
    ds_read_b64_tr_b16 v[202:203], v15 offset:36864
    v_cvt_pk_bf16_f32 v97, v86, v87
    v_mfma_f32_16x16x32_bf16 a[152:155], v[32:35], v[92:95], 0
    v_exp_f32 v88, v88
    v_mfma_f32_16x16x32_bf16 v[56:59], v[164:167], v[92:95], 0
    buffer_load_dwordx4 v26, s[16:19], s43 offen offset:2048 lds
    v_mfma_f32_16x16x32_bf16 v[60:63], v[168:171], v[92:95], 0
    v_exp_f32 v89, v89
    v_mfma_f32_16x16x32_bf16 a[96:99], v[172:175], v[92:95], 0
    ds_read_b64_tr_b16 v[206:207], v16 offset:36864
    v_cvt_pk_bf16_f32 v98, v88, v89
    v_mfma_f32_16x16x32_bf16 a[100:103], v[176:179], v[92:95], 0
    v_exp_f32 v90, v90
    v_mfma_f32_16x16x32_bf16 a[104:107], v[180:183], v[92:95], 0
    buffer_load_dwordx4 v27, s[16:19], s43 offen offset:3072 lds
    v_mfma_f32_16x16x32_bf16 a[108:111], v[184:187], v[92:95], 0
    v_exp_f32 v91, v91
    v_mfma_f32_16x16x32_bf16 a[112:115], v[188:191], v[92:95], 0
    ds_read_b64_tr_b16 v[210:211], v17 offset:36864
    v_cvt_pk_bf16_f32 v99, v90, v91
    v_mfma_f32_16x16x32_bf16 a[116:119], v[192:195], v[92:95], 0
    ds_read_b64_tr_b16 v[214:215], v18 offset:36864
    ds_read_b64_tr_b16 v[218:219], v19 offset:36864
    v_mfma_f32_16x16x32_bf16 v[84:87], a[120:123], a[192:195], v[44:47]
    v_exp_f32 v76, v76
    v_mfma_f32_16x16x32_bf16 v[84:87], a[124:127], a[196:199], v[84:87]
    ds_read_b64_tr_b16 v[222:223], v20 offset:36864
    v_mfma_f32_16x16x32_bf16 v[84:87], a[128:131], a[200:203], v[84:87]
    v_exp_f32 v77, v77
    v_mfma_f32_16x16x32_bf16 v[84:87], a[132:135], a[204:207], v[84:87]
    s_add_u32 s43, s43, 4096
    ds_read_b64_tr_b16 v[226:227], v21 offset:36864
    v_cvt_pk_bf16_f32 v92, v76, v77
    v_mfma_f32_16x16x32_bf16 v[88:91], a[136:139], a[192:195], v[44:47]
    s_add_u32 m0, s37, 69632
    v_exp_f32 v78, v78
    v_mfma_f32_16x16x32_bf16 v[88:91], a[140:143], a[196:199], v[88:91]
    buffer_load_dwordx4 v26, s[16:19], s43 offen offset:0 lds
    v_mfma_f32_16x16x32_bf16 v[88:91], a[144:147], a[200:203], v[88:91]
    v_exp_f32 v79, v79
    v_mfma_f32_16x16x32_bf16 v[88:91], a[148:151], a[204:207], v[88:91]
    v_cvt_pk_bf16_f32 v93, v78, v79
    v_mfma_f32_16x16x32_bf16 a[240:243], v[32:35], v[96:99], a[240:243]
    s_waitcnt lgkmcnt(2)
    v_exp_f32 v80, v80
    v_mfma_f32_16x16x32_bf16 v[132:135], v[196:199], v[96:99], v[132:135]
    buffer_load_dwordx4 v27, s[16:19], s43 offen offset:1024 lds
    v_mfma_f32_16x16x32_bf16 v[136:139], v[200:203], v[96:99], v[136:139]
    v_exp_f32 v81, v81
    v_mfma_f32_16x16x32_bf16 a[0:3], v[204:207], v[96:99], a[0:3]
    v_cvt_pk_bf16_f32 v94, v80, v81
    v_mfma_f32_16x16x32_bf16 a[4:7], v[208:211], v[96:99], a[4:7]
    v_exp_f32 v82, v82
    v_mfma_f32_16x16x32_bf16 a[8:11], v[212:215], v[96:99], a[8:11]
    s_waitcnt lgkmcnt(0)
    buffer_load_dwordx4 v26, s[16:19], s43 offen offset:2048 lds
    v_mfma_f32_16x16x32_bf16 a[12:15], v[216:219], v[96:99], a[12:15]
    v_exp_f32 v83, v83
    v_mfma_f32_16x16x32_bf16 a[16:19], v[220:223], v[96:99], a[16:19]
    v_cvt_pk_bf16_f32 v95, v82, v83
    v_mfma_f32_16x16x32_bf16 a[20:23], v[224:227], v[96:99], a[20:23]
    buffer_load_dwordx4 v27, s[16:19], s43 offen offset:3072 lds
    v_mfma_f32_16x16x32_bf16 v[76:79], a[120:123], a[208:211], v[48:51]
    s_bfe_u32 s42, s98, 0x3000c
    s_lshl_b32 s42, s42, 13
    s_add_u32 m0, s37, 32768
    v_exp_f32 v84, v84
    v_mfma_f32_16x16x32_bf16 v[76:79], a[124:127], a[212:215], v[76:79]
    buffer_load_dwordx4 v22, s[12:15], s42 offen offset:0 lds
    v_mfma_f32_16x16x32_bf16 v[76:79], a[128:131], a[216:219], v[76:79]
    v_exp_f32 v85, v85
    v_mfma_f32_16x16x32_bf16 v[76:79], a[132:135], a[220:223], v[76:79]
    s_waitcnt vmcnt(13)
    ds_read_b128 v[100:103], v10 offset:0
    v_cvt_pk_bf16_f32 v96, v84, v85
    v_mfma_f32_16x16x32_bf16 v[80:83], a[136:139], a[208:211], v[48:51]
    v_exp_f32 v86, v86
    v_mfma_f32_16x16x32_bf16 v[80:83], a[140:143], a[212:215], v[80:83]
    buffer_load_dwordx4 v23, s[12:15], s42 offen offset:1024 lds
    v_mfma_f32_16x16x32_bf16 v[80:83], a[144:147], a[216:219], v[80:83]
    v_exp_f32 v87, v87
    v_mfma_f32_16x16x32_bf16 v[80:83], a[148:151], a[220:223], v[80:83]
    ds_read_b128 v[104:107], v11 offset:0
    v_cvt_pk_bf16_f32 v97, v86, v87
    v_mfma_f32_16x16x32_bf16 a[244:247], v[32:35], v[92:95], a[244:247]
    v_exp_f32 v88, v88
    v_mfma_f32_16x16x32_bf16 v[140:143], v[196:199], v[92:95], v[140:143]
    buffer_load_dwordx4 v24, s[12:15], s42 offen offset:2048 lds
    v_mfma_f32_16x16x32_bf16 v[144:147], v[200:203], v[92:95], v[144:147]
    v_exp_f32 v89, v89
    v_mfma_f32_16x16x32_bf16 a[24:27], v[204:207], v[92:95], a[24:27]
    ds_read_b128 v[108:111], v12 offset:0
    v_cvt_pk_bf16_f32 v98, v88, v89
    v_mfma_f32_16x16x32_bf16 a[28:31], v[208:211], v[92:95], a[28:31]
    v_exp_f32 v90, v90
    v_mfma_f32_16x16x32_bf16 a[32:35], v[212:215], v[92:95], a[32:35]
    buffer_load_dwordx4 v25, s[12:15], s42 offen offset:3072 lds
    v_mfma_f32_16x16x32_bf16 a[36:39], v[216:219], v[92:95], a[36:39]
    v_exp_f32 v91, v91
    v_mfma_f32_16x16x32_bf16 a[40:43], v[220:223], v[92:95], a[40:43]
    ds_read_b128 v[112:115], v13 offset:0
    v_cvt_pk_bf16_f32 v99, v90, v91
    v_mfma_f32_16x16x32_bf16 a[44:47], v[224:227], v[92:95], a[44:47]
    v_mov_b32 v9, 0
    v_mfma_f32_16x16x32_bf16 v[84:87], a[120:123], a[224:227], v[52:55]
    v_exp_f32 v76, v76
    v_mfma_f32_16x16x32_bf16 v[84:87], a[124:127], a[228:231], v[84:87]
    s_waitcnt vmcnt(12)
    ds_read_b128 v[116:119], v10 offset:4096
    v_mfma_f32_16x16x32_bf16 v[84:87], a[128:131], a[232:235], v[84:87]
    v_exp_f32 v77, v77
    v_mfma_f32_16x16x32_bf16 v[84:87], a[132:135], a[236:239], v[84:87]
    ds_read_b128 v[120:123], v11 offset:4096
    v_cvt_pk_bf16_f32 v92, v76, v77
    v_mfma_f32_16x16x32_bf16 v[88:91], a[136:139], a[224:227], v[52:55]
    v_exp_f32 v78, v78
    v_mfma_f32_16x16x32_bf16 v[88:91], a[140:143], a[228:231], v[88:91]
    buffer_load_dwordx2 v[250:251], v9, s[60:63], 0 offen offset:0 sc1
    v_mfma_f32_16x16x32_bf16 v[88:91], a[144:147], a[232:235], v[88:91]
    v_exp_f32 v79, v79
    v_mfma_f32_16x16x32_bf16 v[88:91], a[148:151], a[236:239], v[88:91]
    s_add_u32 s42, s42, 4096
    ds_read_b128 v[124:127], v12 offset:4096
    v_cvt_pk_bf16_f32 v93, v78, v79
    v_mfma_f32_16x16x32_bf16 a[248:251], v[32:35], v[96:99], a[248:251]
    s_add_u32 m0, s37, 36864
    v_exp_f32 v80, v80
    v_mfma_f32_16x16x32_bf16 v[148:151], v[196:199], v[96:99], v[148:151]
    buffer_load_dwordx4 v22, s[12:15], s42 offen offset:0 lds
    v_mfma_f32_16x16x32_bf16 v[152:155], v[200:203], v[96:99], v[152:155]
    v_exp_f32 v81, v81
    v_mfma_f32_16x16x32_bf16 a[48:51], v[204:207], v[96:99], a[48:51]
    ds_read_b128 v[128:131], v13 offset:4096
    v_cvt_pk_bf16_f32 v94, v80, v81
    v_mfma_f32_16x16x32_bf16 a[52:55], v[208:211], v[96:99], a[52:55]
    v_exp_f32 v82, v82
    v_mfma_f32_16x16x32_bf16 a[56:59], v[212:215], v[96:99], a[56:59]
    buffer_load_dwordx4 v23, s[12:15], s42 offen offset:1024 lds
    v_mfma_f32_16x16x32_bf16 a[60:63], v[216:219], v[96:99], a[60:63]
    v_exp_f32 v83, v83
    v_mfma_f32_16x16x32_bf16 a[64:67], v[220:223], v[96:99], a[64:67]
    s_waitcnt vmcnt(11)
    ds_read_b64_tr_b16 v[164:165], v14 offset:0
    v_cvt_pk_bf16_f32 v95, v82, v83
    v_mfma_f32_16x16x32_bf16 a[68:71], v[224:227], v[96:99], a[68:71]
    s_waitcnt lgkmcnt(5)
    buffer_load_dwordx4 v24, s[12:15], s42 offen offset:2048 lds
    ds_read_b64_tr_b16 v[168:169], v15 offset:0
    v_mfma_f32_16x16x32_bf16 v[76:79], v[100:103], a[160:163], v[36:39]
    v_exp_f32 v84, v84
    v_mfma_f32_16x16x32_bf16 v[76:79], v[104:107], a[164:167], v[76:79]
    buffer_load_dwordx4 v25, s[12:15], s42 offen offset:3072 lds
    v_mfma_f32_16x16x32_bf16 v[76:79], v[108:111], a[168:171], v[76:79]
    s_bfe_u32 s43, s98, 0x3000c
    v_exp_f32 v85, v85
    v_mfma_f32_16x16x32_bf16 v[76:79], v[112:115], a[172:175], v[76:79]
    s_lshl_b32 s43, s43, 13
    ds_read_b64_tr_b16 v[172:173], v16 offset:0
    v_cvt_pk_bf16_f32 v96, v84, v85
    s_waitcnt lgkmcnt(3)
    v_mfma_f32_16x16x32_bf16 v[80:83], v[116:119], a[160:163], v[36:39]
    s_add_u32 m0, s37, 98304
    v_exp_f32 v86, v86
    v_mfma_f32_16x16x32_bf16 v[80:83], v[120:123], a[164:167], v[80:83]
    buffer_load_dwordx4 v26, s[16:19], s43 offen offset:0 lds
    v_mfma_f32_16x16x32_bf16 v[80:83], v[124:127], a[168:171], v[80:83]
    v_exp_f32 v87, v87
    v_mfma_f32_16x16x32_bf16 v[80:83], v[128:131], a[172:175], v[80:83]
    ds_read_b64_tr_b16 v[176:177], v17 offset:0
    v_cvt_pk_bf16_f32 v97, v86, v87
    v_mfma_f32_16x16x32_bf16 a[252:255], v[32:35], v[92:95], a[252:255]
    v_exp_f32 v88, v88
    v_mfma_f32_16x16x32_bf16 v[156:159], v[196:199], v[92:95], v[156:159]
    buffer_load_dwordx4 v27, s[16:19], s43 offen offset:1024 lds
    v_mfma_f32_16x16x32_bf16 v[160:163], v[200:203], v[92:95], v[160:163]
    v_exp_f32 v89, v89
    v_mfma_f32_16x16x32_bf16 a[72:75], v[204:207], v[92:95], a[72:75]
    ds_read_b64_tr_b16 v[180:181], v18 offset:0
    v_cvt_pk_bf16_f32 v98, v88, v89
    v_mfma_f32_16x16x32_bf16 a[76:79], v[208:211], v[92:95], a[76:79]
    v_exp_f32 v90, v90
    v_mfma_f32_16x16x32_bf16 a[80:83], v[212:215], v[92:95], a[80:83]
    buffer_load_dwordx4 v26, s[16:19], s43 offen offset:2048 lds
    v_mfma_f32_16x16x32_bf16 a[84:87], v[216:219], v[92:95], a[84:87]
    v_exp_f32 v91, v91
    v_mfma_f32_16x16x32_bf16 a[88:91], v[220:223], v[92:95], a[88:91]
    ds_read_b64_tr_b16 v[184:185], v19 offset:0
    v_cvt_pk_bf16_f32 v99, v90, v91
    v_mfma_f32_16x16x32_bf16 a[92:95], v[224:227], v[92:95], a[92:95]
    ds_read_b64_tr_b16 v[188:189], v20 offset:0
    ds_read_b64_tr_b16 v[192:193], v21 offset:0
    v_mfma_f32_16x16x32_bf16 v[84:87], v[100:103], a[176:179], v[40:43]
    v_exp_f32 v76, v76
    v_mfma_f32_16x16x32_bf16 v[84:87], v[104:107], a[180:183], v[84:87]
    buffer_load_dwordx4 v27, s[16:19], s43 offen offset:3072 lds
    v_mfma_f32_16x16x32_bf16 v[84:87], v[108:111], a[184:187], v[84:87]
    s_waitcnt vmcnt(13)
    v_exp_f32 v77, v77
    v_mfma_f32_16x16x32_bf16 v[84:87], v[112:115], a[188:191], v[84:87]
    s_add_u32 s43, s43, 4096
    ds_read_b64_tr_b16 v[166:167], v14 offset:4096
    v_cvt_pk_bf16_f32 v92, v76, v77
    v_mfma_f32_16x16x32_bf16 v[88:91], v[116:119], a[176:179], v[40:43]
    s_add_u32 m0, s37, 102400
    v_exp_f32 v78, v78
    v_mfma_f32_16x16x32_bf16 v[88:91], v[120:123], a[180:183], v[88:91]
    buffer_load_dwordx4 v26, s[16:19], s43 offen offset:0 lds
    v_mfma_f32_16x16x32_bf16 v[88:91], v[124:127], a[184:187], v[88:91]
    v_exp_f32 v79, v79
    v_mfma_f32_16x16x32_bf16 v[88:91], v[128:131], a[188:191], v[88:91]
    ds_read_b64_tr_b16 v[170:171], v15 offset:4096
    v_cvt_pk_bf16_f32 v93, v78, v79
    v_mfma_f32_16x16x32_bf16 a[152:155], v[32:35], v[96:99], a[152:155]
    v_exp_f32 v80, v80
    v_mfma_f32_16x16x32_bf16 v[56:59], v[196:199], v[96:99], v[56:59]
    buffer_load_dwordx4 v27, s[16:19], s43 offen offset:1024 lds
    v_mfma_f32_16x16x32_bf16 v[60:63], v[200:203], v[96:99], v[60:63]
    v_exp_f32 v81, v81
    v_mfma_f32_16x16x32_bf16 a[96:99], v[204:207], v[96:99], a[96:99]
    ds_read_b64_tr_b16 v[174:175], v16 offset:4096
    v_cvt_pk_bf16_f32 v94, v80, v81
    v_mfma_f32_16x16x32_bf16 a[100:103], v[208:211], v[96:99], a[100:103]
    v_exp_f32 v82, v82
    v_mfma_f32_16x16x32_bf16 a[104:107], v[212:215], v[96:99], a[104:107]
    buffer_load_dwordx4 v26, s[16:19], s43 offen offset:2048 lds
    v_mfma_f32_16x16x32_bf16 a[108:111], v[216:219], v[96:99], a[108:111]
    v_exp_f32 v83, v83
    v_mfma_f32_16x16x32_bf16 a[112:115], v[220:223], v[96:99], a[112:115]
    ds_read_b64_tr_b16 v[178:179], v17 offset:4096
    v_cvt_pk_bf16_f32 v95, v82, v83
    v_mfma_f32_16x16x32_bf16 a[116:119], v[224:227], v[96:99], a[116:119]
    ds_read_b64_tr_b16 v[182:183], v18 offset:4096
    ds_read_b64_tr_b16 v[186:187], v19 offset:4096
    v_mfma_f32_16x16x32_bf16 v[76:79], v[100:103], a[192:195], v[44:47]
    v_exp_f32 v84, v84
    v_mfma_f32_16x16x32_bf16 v[76:79], v[104:107], a[196:199], v[76:79]
    ds_read_b64_tr_b16 v[190:191], v20 offset:4096
    v_mfma_f32_16x16x32_bf16 v[76:79], v[108:111], a[200:203], v[76:79]
    v_exp_f32 v85, v85
    v_mfma_f32_16x16x32_bf16 v[76:79], v[112:115], a[204:207], v[76:79]
    ds_read_b64_tr_b16 v[194:195], v21 offset:4096
    v_cvt_pk_bf16_f32 v96, v84, v85
    v_mfma_f32_16x16x32_bf16 v[80:83], v[116:119], a[192:195], v[44:47]
    v_exp_f32 v86, v86
    v_mfma_f32_16x16x32_bf16 v[80:83], v[120:123], a[196:199], v[80:83]
    buffer_load_dwordx4 v27, s[16:19], s43 offen offset:3072 lds
    v_mfma_f32_16x16x32_bf16 v[80:83], v[124:127], a[200:203], v[80:83]
    s_bfe_u32 s42, s98, 0x30010
    v_exp_f32 v87, v87
    v_mfma_f32_16x16x32_bf16 v[80:83], v[128:131], a[204:207], v[80:83]
    s_lshl_b32 s42, s42, 13
    v_cvt_pk_bf16_f32 v97, v86, v87
    v_mfma_f32_16x16x32_bf16 a[240:243], v[32:35], v[92:95], a[240:243]
    s_add_u32 m0, s37, 0
    v_exp_f32 v88, v88
    s_waitcnt lgkmcnt(2)
    v_mfma_f32_16x16x32_bf16 v[132:135], v[164:167], v[92:95], v[132:135]
    buffer_load_dwordx4 v22, s[12:15], s42 offen offset:0 lds
    v_mfma_f32_16x16x32_bf16 v[136:139], v[168:171], v[92:95], v[136:139]
    v_exp_f32 v89, v89
    v_mfma_f32_16x16x32_bf16 a[0:3], v[172:175], v[92:95], a[0:3]
    v_cvt_pk_bf16_f32 v98, v88, v89
    v_mfma_f32_16x16x32_bf16 a[4:7], v[176:179], v[92:95], a[4:7]
    v_exp_f32 v90, v90
    v_mfma_f32_16x16x32_bf16 a[8:11], v[180:183], v[92:95], a[8:11]
    s_waitcnt lgkmcnt(0)
    buffer_load_dwordx4 v23, s[12:15], s42 offen offset:1024 lds
    v_mfma_f32_16x16x32_bf16 a[12:15], v[184:187], v[92:95], a[12:15]
    v_exp_f32 v91, v91
    v_mfma_f32_16x16x32_bf16 a[16:19], v[188:191], v[92:95], a[16:19]
    v_cvt_pk_bf16_f32 v99, v90, v91
    v_mfma_f32_16x16x32_bf16 a[20:23], v[192:195], v[92:95], a[20:23]
    buffer_load_dwordx4 v24, s[12:15], s42 offen offset:2048 lds
    v_mfma_f32_16x16x32_bf16 v[84:87], v[100:103], a[208:211], v[48:51]
    v_exp_f32 v76, v76
    v_mfma_f32_16x16x32_bf16 v[84:87], v[104:107], a[212:215], v[84:87]
    buffer_load_dwordx4 v25, s[12:15], s42 offen offset:3072 lds
    v_mfma_f32_16x16x32_bf16 v[84:87], v[108:111], a[216:219], v[84:87]
    s_waitcnt vmcnt(17)
    v_exp_f32 v77, v77
    v_mfma_f32_16x16x32_bf16 v[84:87], v[112:115], a[220:223], v[84:87]
    s_add_u32 s42, s42, 4096
    ds_read_b128 a[120:123], v10 offset:32768
    v_cvt_pk_bf16_f32 v92, v76, v77
    v_mfma_f32_16x16x32_bf16 v[88:91], v[116:119], a[208:211], v[48:51]
    s_add_u32 m0, s37, 4096
    v_exp_f32 v78, v78
    v_mfma_f32_16x16x32_bf16 v[88:91], v[120:123], a[212:215], v[88:91]
    buffer_load_dwordx4 v22, s[12:15], s42 offen offset:0 lds
    v_mfma_f32_16x16x32_bf16 v[88:91], v[124:127], a[216:219], v[88:91]
    v_exp_f32 v79, v79
    v_mfma_f32_16x16x32_bf16 v[88:91], v[128:131], a[220:223], v[88:91]
    ds_read_b128 a[124:127], v11 offset:32768
    v_cvt_pk_bf16_f32 v93, v78, v79
    v_mfma_f32_16x16x32_bf16 a[244:247], v[32:35], v[96:99], a[244:247]
    v_exp_f32 v80, v80
    v_mfma_f32_16x16x32_bf16 v[140:143], v[164:167], v[96:99], v[140:143]
    buffer_load_dwordx4 v23, s[12:15], s42 offen offset:1024 lds
    v_mfma_f32_16x16x32_bf16 v[144:147], v[168:171], v[96:99], v[144:147]
    v_exp_f32 v81, v81
    v_mfma_f32_16x16x32_bf16 a[24:27], v[172:175], v[96:99], a[24:27]
    ds_read_b128 a[128:131], v12 offset:32768
    v_cvt_pk_bf16_f32 v94, v80, v81
    v_mfma_f32_16x16x32_bf16 a[28:31], v[176:179], v[96:99], a[28:31]
    v_exp_f32 v82, v82
    v_mfma_f32_16x16x32_bf16 a[32:35], v[180:183], v[96:99], a[32:35]
    buffer_load_dwordx4 v24, s[12:15], s42 offen offset:2048 lds
    v_mfma_f32_16x16x32_bf16 a[36:39], v[184:187], v[96:99], a[36:39]
    v_exp_f32 v83, v83
    v_mfma_f32_16x16x32_bf16 a[40:43], v[188:191], v[96:99], a[40:43]
    ds_read_b128 a[132:135], v13 offset:32768
    v_cvt_pk_bf16_f32 v95, v82, v83
    v_mfma_f32_16x16x32_bf16 a[44:47], v[192:195], v[96:99], a[44:47]
    s_waitcnt vmcnt(19)
    v_readfirstlane_b32 s96, v250
    v_readfirstlane_b32 s97, v251
    s_nop 1
    s_cmp_eq_u64 s[96:97], 0
    s_cbranch_scc1 L_spin_n
L_back_n:
    v_mfma_f32_16x16x32_bf16 v[76:79], v[100:103], a[224:227], v[52:55]
    v_exp_f32 v84, v84
    v_mfma_f32_16x16x32_bf16 v[76:79], v[104:107], a[228:231], v[76:79]
    s_waitcnt vmcnt(15)
    ds_read_b128 a[136:139], v10 offset:36864
    v_mfma_f32_16x16x32_bf16 v[76:79], v[108:111], a[232:235], v[76:79]
    v_exp_f32 v85, v85
    v_mfma_f32_16x16x32_bf16 v[76:79], v[112:115], a[236:239], v[76:79]
    ds_read_b128 a[140:143], v11 offset:36864
    v_cvt_pk_bf16_f32 v96, v84, v85
    v_mfma_f32_16x16x32_bf16 v[80:83], v[116:119], a[224:227], v[52:55]
    v_exp_f32 v86, v86
    v_mfma_f32_16x16x32_bf16 v[80:83], v[120:123], a[228:231], v[80:83]
    buffer_load_dwordx4 v25, s[12:15], s42 offen offset:3072 lds
    v_mfma_f32_16x16x32_bf16 v[80:83], v[124:127], a[232:235], v[80:83]
    s_bfe_u32 s43, s98, 0x30010
    v_exp_f32 v87, v87
    v_mfma_f32_16x16x32_bf16 v[80:83], v[128:131], a[236:239], v[80:83]
    s_lshl_b32 s43, s43, 13
    ds_read_b128 a[144:147], v12 offset:36864
    v_cvt_pk_bf16_f32 v97, v86, v87
    v_mfma_f32_16x16x32_bf16 a[248:251], v[32:35], v[92:95], a[248:251]
    s_add_u32 m0, s37, 65536
    v_exp_f32 v88, v88
    v_mfma_f32_16x16x32_bf16 v[148:151], v[164:167], v[92:95], v[148:151]
    buffer_load_dwordx4 v26, s[16:19], s43 offen offset:0 lds
    v_mfma_f32_16x16x32_bf16 v[152:155], v[168:171], v[92:95], v[152:155]
    v_exp_f32 v89, v89
    v_mfma_f32_16x16x32_bf16 a[48:51], v[172:175], v[92:95], a[48:51]
    ds_read_b128 a[148:151], v13 offset:36864
    v_cvt_pk_bf16_f32 v98, v88, v89
    v_mfma_f32_16x16x32_bf16 a[52:55], v[176:179], v[92:95], a[52:55]
    v_exp_f32 v90, v90
    v_mfma_f32_16x16x32_bf16 a[56:59], v[180:183], v[92:95], a[56:59]
    buffer_load_dwordx4 v27, s[16:19], s43 offen offset:1024 lds
    v_mfma_f32_16x16x32_bf16 a[60:63], v[184:187], v[92:95], a[60:63]
    v_exp_f32 v91, v91
    v_mfma_f32_16x16x32_bf16 a[64:67], v[188:191], v[92:95], a[64:67]
    s_waitcnt vmcnt(14)
    ds_read_b64_tr_b16 v[196:197], v14 offset:32768
    v_cvt_pk_bf16_f32 v99, v90, v91
    v_mfma_f32_16x16x32_bf16 a[68:71], v[192:195], v[92:95], a[68:71]
    s_waitcnt lgkmcnt(5)
    buffer_load_dwordx4 v26, s[16:19], s43 offen offset:2048 lds
    ds_read_b64_tr_b16 v[200:201], v15 offset:32768
    v_mfma_f32_16x16x32_bf16 v[84:87], a[120:123], a[160:163], v[36:39]
    v_exp_f32 v76, v76
    v_mfma_f32_16x16x32_bf16 v[84:87], a[124:127], a[164:167], v[84:87]
    buffer_load_dwordx4 v27, s[16:19], s43 offen offset:3072 lds
    v_mfma_f32_16x16x32_bf16 v[84:87], a[128:131], a[168:171], v[84:87]
    s_waitcnt lgkmcnt(2)
    v_exp_f32 v77, v77
    v_mfma_f32_16x16x32_bf16 v[84:87], a[132:135], a[172:175], v[84:87]
    s_add_u32 s43, s43, 4096
    ds_read_b64_tr_b16 v[204:205], v16 offset:32768
    v_cvt_pk_bf16_f32 v92, v76, v77
    v_mfma_f32_16x16x32_bf16 v[88:91], a[136:139], a[160:163], v[36:39]
    s_add_u32 m0, s37, 69632
    v_exp_f32 v78, v78
    v_mfma_f32_16x16x32_bf16 v[88:91], a[140:143], a[164:167], v[88:91]
    buffer_load_dwordx4 v26, s[16:19], s43 offen offset:0 lds
    v_mfma_f32_16x16x32_bf16 v[88:91], a[144:147], a[168:171], v[88:91]
    v_exp_f32 v79, v79
    v_mfma_f32_16x16x32_bf16 v[88:91], a[148:151], a[172:175], v[88:91]
    ds_read_b64_tr_b16 v[208:209], v17 offset:32768
    v_cvt_pk_bf16_f32 v93, v78, v79
    v_mfma_f32_16x16x32_bf16 a[252:255], v[32:35], v[96:99], a[252:255]
    v_exp_f32 v80, v80
    v_mfma_f32_16x16x32_bf16 v[156:159], v[164:167], v[96:99], v[156:159]
    buffer_load_dwordx4 v27, s[16:19], s43 offen offset:1024 lds
    v_mfma_f32_16x16x32_bf16 v[160:163], v[168:171], v[96:99], v[160:163]
    v_exp_f32 v81, v81
    v_mfma_f32_16x16x32_bf16 a[72:75], v[172:175], v[96:99], a[72:75]
    ds_read_b64_tr_b16 v[212:213], v18 offset:32768
    v_cvt_pk_bf16_f32 v94, v80, v81
    v_mfma_f32_16x16x32_bf16 a[76:79], v[176:179], v[96:99], a[76:79]
    v_exp_f32 v82, v82
    v_mfma_f32_16x16x32_bf16 a[80:83], v[180:183], v[96:99], a[80:83]
    buffer_load_dwordx4 v26, s[16:19], s43 offen offset:2048 lds
    v_mfma_f32_16x16x32_bf16 a[84:87], v[184:187], v[96:99], a[84:87]
    v_exp_f32 v83, v83
    v_mfma_f32_16x16x32_bf16 a[88:91], v[188:191], v[96:99], a[88:91]
    ds_read_b64_tr_b16 v[216:217], v19 offset:32768
    v_cvt_pk_bf16_f32 v95, v82, v83
    v_mfma_f32_16x16x32_bf16 a[92:95], v[192:195], v[96:99], a[92:95]
    ds_read_b64_tr_b16 v[220:221], v20 offset:32768
    ds_read_b64_tr_b16 v[224:225], v21 offset:32768
    v_mfma_f32_16x16x32_bf16 v[76:79], a[120:123], a[176:179], v[40:43]
    v_exp_f32 v84, v84
    v_mfma_f32_16x16x32_bf16 v[76:79], a[124:127], a[180:183], v[76:79]
    buffer_load_dwordx4 v27, s[16:19], s43 offen offset:3072 lds
    v_mfma_f32_16x16x32_bf16 v[76:79], a[128:131], a[184:187], v[76:79]
    s_bfe_u32 s42, s98, 0x30014
    v_exp_f32 v85, v85
    v_mfma_f32_16x16x32_bf16 v[76:79], a[132:135], a[188:191], v[76:79]
    s_lshl_b32 s42, s42, 13
    s_waitcnt vmcnt(16)
    ds_read_b64_tr_b16 v[198:199], v14 offset:36864
    v_cvt_pk_bf16_f32 v96, v84, v85
    v_mfma_f32_16x16x32_bf16 v[80:83], a[136:139], a[176:179], v[40:43]
    s_add_u32 m0, s37, 32768
    v_exp_f32 v86, v86
    v_mfma_f32_16x16x32_bf16 v[80:83], a[140:143], a[180:183], v[80:83]
    buffer_load_dwordx4 v22, s[12:15], s42 offen offset:0 lds
    v_mfma_f32_16x16x32_bf16 v[80:83], a[144:147], a[184:187], v[80:83]
    v_exp_f32 v87, v87
    v_mfma_f32_16x16x32_bf16 v[80:83], a[148:151], a[188:191], v[80:83]
    ds_read_b64_tr_b16 v[202:203], v15 offset:36864
    v_cvt_pk_bf16_f32 v97, v86, v87
    v_mfma_f32_16x16x32_bf16 a[152:155], v[32:35], v[92:95], a[152:155]
    v_exp_f32 v88, v88
    v_mfma_f32_16x16x32_bf16 v[56:59], v[164:167], v[92:95], v[56:59]
    buffer_load_dwordx4 v23, s[12:15], s42 offen offset:1024 lds
    v_mfma_f32_16x16x32_bf16 v[60:63], v[168:171], v[92:95], v[60:63]
    v_exp_f32 v89, v89
    v_mfma_f32_16x16x32_bf16 a[96:99], v[172:175], v[92:95], a[96:99]
    ds_read_b64_tr_b16 v[206:207], v16 offset:36864
    v_cvt_pk_bf16_f32 v98, v88, v89
    v_mfma_f32_16x16x32_bf16 a[100:103], v[176:179], v[92:95], a[100:103]
    v_exp_f32 v90, v90
    v_mfma_f32_16x16x32_bf16 a[104:107], v[180:183], v[92:95], a[104:107]
    buffer_load_dwordx4 v24, s[12:15], s42 offen offset:2048 lds
    v_mfma_f32_16x16x32_bf16 a[108:111], v[184:187], v[92:95], a[108:111]
    v_exp_f32 v91, v91
    v_mfma_f32_16x16x32_bf16 a[112:115], v[188:191], v[92:95], a[112:115]
    ds_read_b64_tr_b16 v[210:211], v17 offset:36864
    v_cvt_pk_bf16_f32 v99, v90, v91
    v_mfma_f32_16x16x32_bf16 a[116:119], v[192:195], v[92:95], a[116:119]
    ds_read_b64_tr_b16 v[214:215], v18 offset:36864
    ds_read_b64_tr_b16 v[218:219], v19 offset:36864
    v_mfma_f32_16x16x32_bf16 v[84:87], a[120:123], a[192:195], v[44:47]
    s_mov_b32 s44, 0
    v_exp_f32 v76, v76
    v_mfma_f32_16x16x32_bf16 v[84:87], a[124:127], a[196:199], v[84:87]
    s_mov_b32 s45, 8192
    ds_read_b64_tr_b16 v[222:223], v20 offset:36864
    v_mfma_f32_16x16x32_bf16 v[84:87], a[128:131], a[200:203], v[84:87]
    s_mov_b32 s46, 16384
    v_exp_f32 v77, v77
    v_mfma_f32_16x16x32_bf16 v[84:87], a[132:135], a[204:207], v[84:87]
    s_mov_b32 s47, 24576
    ds_read_b64_tr_b16 v[226:227], v21 offset:36864
    v_cvt_pk_bf16_f32 v92, v76, v77
    v_mfma_f32_16x16x32_bf16 v[88:91], a[136:139], a[192:195], v[44:47]
    s_mov_b32 s48, 32768
    v_exp_f32 v78, v78
    v_mfma_f32_16x16x32_bf16 v[88:91], a[140:143], a[196:199], v[88:91]
    buffer_load_dwordx4 v25, s[12:15], s42 offen offset:3072 lds
    v_mfma_f32_16x16x32_bf16 v[88:91], a[144:147], a[200:203], v[88:91]
    v_exp_f32 v79, v79
    v_mfma_f32_16x16x32_bf16 v[88:91], a[148:151], a[204:207], v[88:91]
    s_add_u32 s42, s42, 4096
    v_cvt_pk_bf16_f32 v93, v78, v79
    v_mfma_f32_16x16x32_bf16 a[240:243], v[32:35], v[96:99], a[240:243]
    s_add_u32 m0, s37, 36864
    v_exp_f32 v80, v80
    s_waitcnt lgkmcnt(2)
    v_mfma_f32_16x16x32_bf16 v[132:135], v[196:199], v[96:99], v[132:135]
    buffer_load_dwordx4 v22, s[12:15], s42 offen offset:0 lds
    v_mfma_f32_16x16x32_bf16 v[136:139], v[200:203], v[96:99], v[136:139]
    v_exp_f32 v81, v81
    v_mfma_f32_16x16x32_bf16 a[0:3], v[204:207], v[96:99], a[0:3]
    v_cvt_pk_bf16_f32 v94, v80, v81
    v_mfma_f32_16x16x32_bf16 a[4:7], v[208:211], v[96:99], a[4:7]
    v_exp_f32 v82, v82
    v_mfma_f32_16x16x32_bf16 a[8:11], v[212:215], v[96:99], a[8:11]
    s_waitcnt lgkmcnt(0)
    buffer_load_dwordx4 v23, s[12:15], s42 offen offset:1024 lds
    v_mfma_f32_16x16x32_bf16 a[12:15], v[216:219], v[96:99], a[12:15]
    v_exp_f32 v83, v83
    v_mfma_f32_16x16x32_bf16 a[16:19], v[220:223], v[96:99], a[16:19]
    v_cvt_pk_bf16_f32 v95, v82, v83
    v_mfma_f32_16x16x32_bf16 a[20:23], v[224:227], v[96:99], a[20:23]
    buffer_load_dwordx4 v24, s[12:15], s42 offen offset:2048 lds
    v_mfma_f32_16x16x32_bf16 v[76:79], a[120:123], a[208:211], v[48:51]
    v_exp_f32 v84, v84
    v_mfma_f32_16x16x32_bf16 v[76:79], a[124:127], a[212:215], v[76:79]
    buffer_load_dwordx4 v25, s[12:15], s42 offen offset:3072 lds
    v_mfma_f32_16x16x32_bf16 v[76:79], a[128:131], a[216:219], v[76:79]
    s_bfe_u32 s43, s98, 0x30014
    v_exp_f32 v85, v85
    v_mfma_f32_16x16x32_bf16 v[76:79], a[132:135], a[220:223], v[76:79]
    s_lshl_b32 s43, s43, 13
    s_waitcnt vmcnt(20)
    ds_read_b128 v[100:103], v10 offset:0
    v_cvt_pk_bf16_f32 v96, v84, v85
    v_mfma_f32_16x16x32_bf16 v[80:83], a[136:139], a[208:211], v[48:51]
    s_add_u32 m0, s37, 98304
    v_exp_f32 v86, v86
    v_mfma_f32_16x16x32_bf16 v[80:83], a[140:143], a[212:215], v[80:83]
    buffer_load_dwordx4 v26, s[16:19], s43 offen offset:0 lds
    v_mfma_f32_16x16x32_bf16 v[80:83], a[144:147], a[216:219], v[80:83]
    v_exp_f32 v87, v87
    v_mfma_f32_16x16x32_bf16 v[80:83], a[148:151], a[220:223], v[80:83]
    ds_read_b128 v[104:107], v11 offset:0
    v_cvt_pk_bf16_f32 v97, v86, v87
    v_mfma_f32_16x16x32_bf16 a[244:247], v[32:35], v[92:95], a[244:247]
    v_exp_f32 v88, v88
    v_mfma_f32_16x16x32_bf16 v[140:143], v[196:199], v[92:95], v[140:143]
    buffer_load_dwordx4 v27, s[16:19], s43 offen offset:1024 lds
    v_mfma_f32_16x16x32_bf16 v[144:147], v[200:203], v[92:95], v[144:147]
    v_exp_f32 v89, v89
    v_mfma_f32_16x16x32_bf16 a[24:27], v[204:207], v[92:95], a[24:27]
    ds_read_b128 v[108:111], v12 offset:0
    v_cvt_pk_bf16_f32 v98, v88, v89
    v_mfma_f32_16x16x32_bf16 a[28:31], v[208:211], v[92:95], a[28:31]
    v_exp_f32 v90, v90
    v_mfma_f32_16x16x32_bf16 a[32:35], v[212:215], v[92:95], a[32:35]
    buffer_load_dwordx4 v26, s[16:19], s43 offen offset:2048 lds
    v_mfma_f32_16x16x32_bf16 a[36:39], v[216:219], v[92:95], a[36:39]
    v_exp_f32 v91, v91
    v_mfma_f32_16x16x32_bf16 a[40:43], v[220:223], v[92:95], a[40:43]
    ds_read_b128 v[112:115], v13 offset:0
    v_cvt_pk_bf16_f32 v99, v90, v91
    v_mfma_f32_16x16x32_bf16 a[44:47], v[224:227], v[92:95], a[44:47]
    v_mfma_f32_16x16x32_bf16 v[84:87], a[120:123], a[224:227], v[52:55]
    v_exp_f32 v76, v76
    v_mfma_f32_16x16x32_bf16 v[84:87], a[124:127], a[228:231], v[84:87]
    s_waitcnt vmcnt(19)
    ds_read_b128 v[116:119], v10 offset:4096
    v_mfma_f32_16x16x32_bf16 v[84:87], a[128:131], a[232:235], v[84:87]
    v_exp_f32 v77, v77
    v_mfma_f32_16x16x32_bf16 v[84:87], a[132:135], a[236:239], v[84:87]
    ds_read_b128 v[120:123], v11 offset:4096
    v_cvt_pk_bf16_f32 v92, v76, v77
    v_mfma_f32_16x16x32_bf16 v[88:91], a[136:139], a[224:227], v[52:55]
    v_exp_f32 v78, v78
    v_mfma_f32_16x16x32_bf16 v[88:91], a[140:143], a[228:231], v[88:91]
    buffer_load_dwordx4 v27, s[16:19], s43 offen offset:3072 lds
    v_mfma_f32_16x16x32_bf16 v[88:91], a[144:147], a[232:235], v[88:91]
    v_exp_f32 v79, v79
    v_mfma_f32_16x16x32_bf16 v[88:91], a[148:151], a[236:239], v[88:91]
    s_add_u32 s43, s43, 4096
    ds_read_b128 v[124:127], v12 offset:4096
    v_cvt_pk_bf16_f32 v93, v78, v79
    v_mfma_f32_16x16x32_bf16 a[248:251], v[32:35], v[96:99], a[248:251]
    s_add_u32 m0, s37, 102400
    v_exp_f32 v80, v80
    v_mfma_f32_16x16x32_bf16 v[148:151], v[196:199], v[96:99], v[148:151]
    buffer_load_dwordx4 v26, s[16:19], s43 offen offset:0 lds
    v_mfma_f32_16x16x32_bf16 v[152:155], v[200:203], v[96:99], v[152:155]
    v_exp_f32 v81, v81
    v_mfma_f32_16x16x32_bf16 a[48:51], v[204:207], v[96:99], a[48:51]
    ds_read_b128 v[128:131], v13 offset:4096
    v_cvt_pk_bf16_f32 v94, v80, v81
    v_mfma_f32_16x16x32_bf16 a[52:55], v[208:211], v[96:99], a[52:55]
    v_exp_f32 v82, v82
    v_mfma_f32_16x16x32_bf16 a[56:59], v[212:215], v[96:99], a[56:59]
    buffer_load_dwordx4 v27, s[16:19], s43 offen offset:1024 lds
    v_mfma_f32_16x16x32_bf16 a[60:63], v[216:219], v[96:99], a[60:63]
    v_exp_f32 v83, v83
    v_mfma_f32_16x16x32_bf16 a[64:67], v[220:223], v[96:99], a[64:67]
    s_waitcnt vmcnt(18)
    ds_read_b64_tr_b16 v[164:165], v14 offset:0
    v_cvt_pk_bf16_f32 v95, v82, v83
    v_mfma_f32_16x16x32_bf16 a[68:71], v[224:227], v[96:99], a[68:71]
    s_waitcnt lgkmcnt(5)
    buffer_load_dwordx4 v26, s[16:19], s43 offen offset:2048 lds
    ds_read_b64_tr_b16 v[168:169], v15 offset:0
    v_mfma_f32_16x16x32_bf16 v[76:79], v[100:103], a[160:163], v[36:39]
    v_exp_f32 v84, v84
    v_mfma_f32_16x16x32_bf16 v[76:79], v[104:107], a[164:167], v[76:79]
    buffer_load_dwordx4 v27, s[16:19], s43 offen offset:3072 lds
    v_mfma_f32_16x16x32_bf16 v[76:79], v[108:111], a[168:171], v[76:79]
    s_bfe_u32 s42, s98, 0x30018
    v_exp_f32 v85, v85
    v_mfma_f32_16x16x32_bf16 v[76:79], v[112:115], a[172:175], v[76:79]
    s_lshl_b32 s42, s42, 13
    ds_read_b64_tr_b16 v[172:173], v16 offset:0
    v_cvt_pk_bf16_f32 v96, v84, v85
    s_waitcnt lgkmcnt(3)
    v_mfma_f32_16x16x32_bf16 v[80:83], v[116:119], a[160:163], v[36:39]
    s_add_u32 m0, s37, 0
    v_exp_f32 v86, v86
    v_mfma_f32_16x16x32_bf16 v[80:83], v[120:123], a[164:167], v[80:83]
    buffer_load_dwordx4 v22, s[12:15], s42 offen offset:0 lds
    v_mfma_f32_16x16x32_bf16 v[80:83], v[124:127], a[168:171], v[80:83]
    v_exp_f32 v87, v87
    v_mfma_f32_16x16x32_bf16 v[80:83], v[128:131], a[172:175], v[80:83]
    ds_read_b64_tr_b16 v[176:177], v17 offset:0
    v_cvt_pk_bf16_f32 v97, v86, v87
    v_mfma_f32_16x16x32_bf16 a[252:255], v[32:35], v[92:95], a[252:255]
    v_exp_f32 v88, v88
    v_mfma_f32_16x16x32_bf16 v[156:159], v[196:199], v[92:95], v[156:159]
    buffer_load_dwordx4 v23, s[12:15], s42 offen offset:1024 lds
    v_mfma_f32_16x16x32_bf16 v[160:163], v[200:203], v[92:95], v[160:163]
    v_exp_f32 v89, v89
    v_mfma_f32_16x16x32_bf16 a[72:75], v[204:207], v[92:95], a[72:75]
    ds_read_b64_tr_b16 v[180:181], v18 offset:0
    v_cvt_pk_bf16_f32 v98, v88, v89
    v_mfma_f32_16x16x32_bf16 a[76:79], v[208:211], v[92:95], a[76:79]
    v_exp_f32 v90, v90
    v_mfma_f32_16x16x32_bf16 a[80:83], v[212:215], v[92:95], a[80:83]
    buffer_load_dwordx4 v24, s[12:15], s42 offen offset:2048 lds
    v_mfma_f32_16x16x32_bf16 a[84:87], v[216:219], v[92:95], a[84:87]
    v_exp_f32 v91, v91
    v_mfma_f32_16x16x32_bf16 a[88:91], v[220:223], v[92:95], a[88:91]
    ds_read_b64_tr_b16 v[184:185], v19 offset:0
    v_cvt_pk_bf16_f32 v99, v90, v91
    v_mfma_f32_16x16x32_bf16 a[92:95], v[224:227], v[92:95], a[92:95]
    ds_read_b64_tr_b16 v[188:189], v20 offset:0
    ds_read_b64_tr_b16 v[192:193], v21 offset:0
    v_mfma_f32_16x16x32_bf16 v[84:87], v[100:103], a[176:179], v[40:43]
    v_exp_f32 v76, v76
    v_mfma_f32_16x16x32_bf16 v[84:87], v[104:107], a[180:183], v[84:87]
    buffer_load_dwordx4 v25, s[12:15], s42 offen offset:3072 lds
    v_mfma_f32_16x16x32_bf16 v[84:87], v[108:111], a[184:187], v[84:87]
    s_waitcnt vmcnt(20)
    v_exp_f32 v77, v77
    v_mfma_f32_16x16x32_bf16 v[84:87], v[112:115], a[188:191], v[84:87]
    s_add_u32 s42, s42, 4096
    ds_read_b64_tr_b16 v[166:167], v14 offset:4096
    v_cvt_pk_bf16_f32 v92, v76, v77
    v_mfma_f32_16x16x32_bf16 v[88:91], v[116:119], a[176:179], v[40:43]
    s_add_u32 m0, s37, 4096
    v_exp_f32 v78, v78
    v_mfma_f32_16x16x32_bf16 v[88:91], v[120:123], a[180:183], v[88:91]
    buffer_load_dwordx4 v22, s[12:15], s42 offen offset:0 lds
    v_mfma_f32_16x16x32_bf16 v[88:91], v[124:127], a[184:187], v[88:91]
    v_exp_f32 v79, v79
    v_mfma_f32_16x16x32_bf16 v[88:91], v[128:131], a[188:191], v[88:91]
    ds_read_b64_tr_b16 v[170:171], v15 offset:4096
    v_cvt_pk_bf16_f32 v93, v78, v79
    v_mfma_f32_16x16x32_bf16 a[152:155], v[32:35], v[96:99], a[152:155]
    v_exp_f32 v80, v80
    v_mfma_f32_16x16x32_bf16 v[56:59], v[196:199], v[96:99], v[56:59]
    buffer_load_dwordx4 v23, s[12:15], s42 offen offset:1024 lds
    v_mfma_f32_16x16x32_bf16 v[60:63], v[200:203], v[96:99], v[60:63]
    v_exp_f32 v81, v81
    v_mfma_f32_16x16x32_bf16 a[96:99], v[204:207], v[96:99], a[96:99]
    ds_read_b64_tr_b16 v[174:175], v16 offset:4096
    v_cvt_pk_bf16_f32 v94, v80, v81
    v_mfma_f32_16x16x32_bf16 a[100:103], v[208:211], v[96:99], a[100:103]
    v_exp_f32 v82, v82
    v_mfma_f32_16x16x32_bf16 a[104:107], v[212:215], v[96:99], a[104:107]
    buffer_load_dwordx4 v24, s[12:15], s42 offen offset:2048 lds
    v_mfma_f32_16x16x32_bf16 a[108:111], v[216:219], v[96:99], a[108:111]
    v_exp_f32 v83, v83
    v_mfma_f32_16x16x32_bf16 a[112:115], v[220:223], v[96:99], a[112:115]
    ds_read_b64_tr_b16 v[178:179], v17 offset:4096
    v_cvt_pk_bf16_f32 v95, v82, v83
    v_mfma_f32_16x16x32_bf16 a[116:119], v[224:227], v[96:99], a[116:119]
    ds_read_b64_tr_b16 v[182:183], v18 offset:4096
    ds_read_b64_tr_b16 v[186:187], v19 offset:4096
    v_mfma_f32_16x16x32_bf16 v[76:79], v[100:103], a[192:195], v[44:47]
    v_exp_f32 v84, v84
    v_mfma_f32_16x16x32_bf16 v[76:79], v[104:107], a[196:199], v[76:79]
    ds_read_b64_tr_b16 v[190:191], v20 offset:4096
    v_mfma_f32_16x16x32_bf16 v[76:79], v[108:111], a[200:203], v[76:79]
    v_exp_f32 v85, v85
    v_mfma_f32_16x16x32_bf16 v[76:79], v[112:115], a[204:207], v[76:79]
    ds_read_b64_tr_b16 v[194:195], v21 offset:4096
    v_cvt_pk_bf16_f32 v96, v84, v85
    v_mfma_f32_16x16x32_bf16 v[80:83], v[116:119], a[192:195], v[44:47]
    v_exp_f32 v86, v86
    v_mfma_f32_16x16x32_bf16 v[80:83], v[120:123], a[196:199], v[80:83]
    buffer_load_dwordx4 v25, s[12:15], s42 offen offset:3072 lds
    v_mfma_f32_16x16x32_bf16 v[80:83], v[124:127], a[200:203], v[80:83]
    s_bfe_u32 s43, s98, 0x30018
    v_exp_f32 v87, v87
    v_mfma_f32_16x16x32_bf16 v[80:83], v[128:131], a[204:207], v[80:83]
    s_lshl_b32 s43, s43, 13
    v_cvt_pk_bf16_f32 v97, v86, v87
    v_mfma_f32_16x16x32_bf16 a[240:243], v[32:35], v[92:95], a[240:243]
    s_add_u32 m0, s37, 65536
    v_exp_f32 v88, v88
    s_waitcnt lgkmcnt(2)
    v_mfma_f32_16x16x32_bf16 v[132:135], v[164:167], v[92:95], v[132:135]
    buffer_load_dwordx4 v26, s[16:19], s43 offen offset:0 lds
    v_mfma_f32_16x16x32_bf16 v[136:139], v[168:171], v[92:95], v[136:139]
    v_exp_f32 v89, v89
    v_mfma_f32_16x16x32_bf16 a[0:3], v[172:175], v[92:95], a[0:3]
    v_cvt_pk_bf16_f32 v98, v88, v89
    v_mfma_f32_16x16x32_bf16 a[4:7], v[176:179], v[92:95], a[4:7]
    v_exp_f32 v90, v90
    v_mfma_f32_16x16x32_bf16 a[8:11], v[180:183], v[92:95], a[8:11]
    s_waitcnt lgkmcnt(0)
    buffer_load_dwordx4 v27, s[16:19], s43 offen offset:1024 lds
    v_mfma_f32_16x16x32_bf16 a[12:15], v[184:187], v[92:95], a[12:15]
    v_exp_f32 v91, v91
    v_mfma_f32_16x16x32_bf16 a[16:19], v[188:191], v[92:95], a[16:19]
    v_cvt_pk_bf16_f32 v99, v90, v91
    v_mfma_f32_16x16x32_bf16 a[20:23], v[192:195], v[92:95], a[20:23]
    buffer_load_dwordx4 v26, s[16:19], s43 offen offset:2048 lds
    v_mfma_f32_16x16x32_bf16 v[84:87], v[100:103], a[208:211], v[48:51]
    v_exp_f32 v76, v76
    v_mfma_f32_16x16x32_bf16 v[84:87], v[104:107], a[212:215], v[84:87]
    buffer_load_dwordx4 v27, s[16:19], s43 offen offset:3072 lds
    v_mfma_f32_16x16x32_bf16 v[84:87], v[108:111], a[216:219], v[84:87]
    s_waitcnt vmcnt(24)
    v_exp_f32 v77, v77
    v_mfma_f32_16x16x32_bf16 v[84:87], v[112:115], a[220:223], v[84:87]
    s_add_u32 s43, s43, 4096
    ds_read_b128 a[120:123], v10 offset:32768
    v_cvt_pk_bf16_f32 v92, v76, v77
    v_mfma_f32_16x16x32_bf16 v[88:91], v[116:119], a[208:211], v[48:51]
    s_add_u32 m0, s37, 69632
    v_exp_f32 v78, v78
    v_mfma_f32_16x16x32_bf16 v[88:91], v[120:123], a[212:215], v[88:91]
    buffer_load_dwordx4 v26, s[16:19], s43 offen offset:0 lds
    v_mfma_f32_16x16x32_bf16 v[88:91], v[124:127], a[216:219], v[88:91]
    v_exp_f32 v79, v79
    v_mfma_f32_16x16x32_bf16 v[88:91], v[128:131], a[220:223], v[88:91]
    ds_read_b128 a[124:127], v11 offset:32768
    v_cvt_pk_bf16_f32 v93, v78, v79
    v_mfma_f32_16x16x32_bf16 a[244:247], v[32:35], v[96:99], a[244:247]
    v_exp_f32 v80, v80
    v_mfma_f32_16x16x32_bf16 v[140:143], v[164:167], v[96:99], v[140:143]
    buffer_load_dwordx4 v27, s[16:19], s43 offen offset:1024 lds
    v_mfma_f32_16x16x32_bf16 v[144:147], v[168:171], v[96:99], v[144:147]
    v_exp_f32 v81, v81
    v_mfma_f32_16x16x32_bf16 a[24:27], v[172:175], v[96:99], a[24:27]
    ds_read_b128 a[128:131], v12 offset:32768
    v_cvt_pk_bf16_f32 v94, v80, v81
    v_mfma_f32_16x16x32_bf16 a[28:31], v[176:179], v[96:99], a[28:31]
    v_exp_f32 v82, v82
    v_mfma_f32_16x16x32_bf16 a[32:35], v[180:183], v[96:99], a[32:35]
    buffer_load_dwordx4 v26, s[16:19], s43 offen offset:2048 lds
    v_mfma_f32_16x16x32_bf16 a[36:39], v[184:187], v[96:99], a[36:39]
    v_exp_f32 v83, v83
    v_mfma_f32_16x16x32_bf16 a[40:43], v[188:191], v[96:99], a[40:43]
    ds_read_b128 a[132:135], v13 offset:32768
    v_cvt_pk_bf16_f32 v95, v82, v83
    v_mfma_f32_16x16x32_bf16 a[44:47], v[192:195], v[96:99], a[44:47]
    v_mfma_f32_16x16x32_bf16 v[76:79], v[100:103], a[224:227], v[52:55]
    v_exp_f32 v84, v84
    v_mfma_f32_16x16x32_bf16 v[76:79], v[104:107], a[228:231], v[76:79]
    s_waitcnt vmcnt(23)
    ds_read_b128 a[136:139], v10 offset:36864
    v_mfma_f32_16x16x32_bf16 v[76:79], v[108:111], a[232:235], v[76:79]
    v_exp_f32 v85, v85
    v_mfma_f32_16x16x32_bf16 v[76:79], v[112:115], a[236:239], v[76:79]
    ds_read_b128 a[140:143], v11 offset:36864
    v_cvt_pk_bf16_f32 v96, v84, v85
    v_mfma_f32_16x16x32_bf16 v[80:83], v[116:119], a[224:227], v[52:55]
    v_exp_f32 v86, v86
    v_mfma_f32_16x16x32_bf16 v[80:83], v[120:123], a[228:231], v[80:83]
    buffer_load_dwordx4 v27, s[16:19], s43 offen offset:3072 lds
    v_mfma_f32_16x16x32_bf16 v[80:83], v[124:127], a[232:235], v[80:83]
    s_bfe_u32 s42, s98, 0x3001c
    v_exp_f32 v87, v87
    v_mfma_f32_16x16x32_bf16 v[80:83], v[128:131], a[236:239], v[80:83]
    s_lshl_b32 s42, s42, 13
    ds_read_b128 a[144:147], v12 offset:36864
    v_cvt_pk_bf16_f32 v97, v86, v87
    v_mfma_f32_16x16x32_bf16 a[248:251], v[32:35], v[92:95], a[248:251]
    s_add_u32 m0, s37, 32768
    v_exp_f32 v88, v88
    v_mfma_f32_16x16x32_bf16 v[148:151], v[164:167], v[92:95], v[148:151]
    s_waitcnt lgkmcnt(3)
    buffer_load_dwordx4 v22, s[12:15], s42 offen offset:0 lds
    v_mfma_f32_16x16x32_bf16 v[152:155], v[168:171], v[92:95], v[152:155]
    v_exp_f32 v89, v89
    v_mfma_f32_16x16x32_bf16 a[48:51], v[172:175], v[92:95], a[48:51]
    ds_read_b128 a[148:151], v13 offset:36864
    v_cvt_pk_bf16_f32 v98, v88, v89
    v_mfma_f32_16x16x32_bf16 a[52:55], v[176:179], v[92:95], a[52:55]
    v_exp_f32 v90, v90
    v_mfma_f32_16x16x32_bf16 a[56:59], v[180:183], v[92:95], a[56:59]
    buffer_load_dwordx4 v23, s[12:15], s42 offen offset:1024 lds
    v_mfma_f32_16x16x32_bf16 a[60:63], v[184:187], v[92:95], a[60:63]
    v_exp_f32 v91, v91
    v_mfma_f32_16x16x32_bf16 a[64:67], v[188:191], v[92:95], a[64:67]
    s_waitcnt vmcnt(22)
    ds_read_b64_tr_b16 v[196:197], v14 offset:32768
    v_cvt_pk_bf16_f32 v99, v90, v91
    v_mfma_f32_16x16x32_bf16 a[68:71], v[192:195], v[92:95], a[68:71]
    buffer_load_dwordx4 v24, s[12:15], s42 offen offset:2048 lds
    ds_read_b64_tr_b16 v[200:201], v15 offset:32768
    v_mfma_f32_16x16x32_bf16 v[84:87], a[120:123], a[160:163], v[36:39]
    v_exp_f32 v76, v76
    v_mfma_f32_16x16x32_bf16 v[84:87], a[124:127], a[164:167], v[84:87]
    buffer_load_dwordx4 v25, s[12:15], s42 offen offset:3072 lds
    v_mfma_f32_16x16x32_bf16 v[84:87], a[128:131], a[168:171], v[84:87]
    s_waitcnt lgkmcnt(2)
    v_exp_f32 v77, v77
    v_mfma_f32_16x16x32_bf16 v[84:87], a[132:135], a[172:175], v[84:87]
    s_add_u32 s42, s42, 4096
    ds_read_b64_tr_b16 v[204:205], v16 offset:32768
    v_cvt_pk_bf16_f32 v92, v76, v77
    v_mfma_f32_16x16x32_bf16 v[88:91], a[136:139], a[160:163], v[36:39]
    s_add_u32 m0, s37, 36864
    v_exp_f32 v78, v78
    v_mfma_f32_16x16x32_bf16 v[88:91], a[140:143], a[164:167], v[88:91]
    buffer_load_dwordx4 v22, s[12:15], s42 offen offset:0 lds
    v_mfma_f32_16x16x32_bf16 v[88:91], a[144:147], a[168:171], v[88:91]
    v_exp_f32 v79, v79
    v_mfma_f32_16x16x32_bf16 v[88:91], a[148:151], a[172:175], v[88:91]
    ds_read_b64_tr_b16 v[208:209], v17 offset:32768
    v_cvt_pk_bf16_f32 v93, v78, v79
    v_mfma_f32_16x16x32_bf16 a[252:255], v[32:35], v[96:99], a[252:255]
    v_exp_f32 v80, v80
    v_mfma_f32_16x16x32_bf16 v[156:159], v[164:167], v[96:99], v[156:159]
    buffer_load_dwordx4 v23, s[12:15], s42 offen offset:1024 lds
    v_mfma_f32_16x16x32_bf16 v[160:163], v[168:171], v[96:99], v[160:163]
    v_exp_f32 v81, v81
    v_mfma_f32_16x16x32_bf16 a[72:75], v[172:175], v[96:99], a[72:75]
    ds_read_b64_tr_b16 v[212:213], v18 offset:32768
    v_cvt_pk_bf16_f32 v94, v80, v81
    v_mfma_f32_16x16x32_bf16 a[76:79], v[176:179], v[96:99], a[76:79]
    v_exp_f32 v82, v82
    v_mfma_f32_16x16x32_bf16 a[80:83], v[180:183], v[96:99], a[80:83]
    buffer_load_dwordx4 v24, s[12:15], s42 offen offset:2048 lds
    v_mfma_f32_16x16x32_bf16 a[84:87], v[184:187], v[96:99], a[84:87]
    v_exp_f32 v83, v83
    v_mfma_f32_16x16x32_bf16 a[88:91], v[188:191], v[96:99], a[88:91]
    ds_read_b64_tr_b16 v[216:217], v19 offset:32768
    v_cvt_pk_bf16_f32 v95, v82, v83
    v_mfma_f32_16x16x32_bf16 a[92:95], v[192:195], v[96:99], a[92:95]
    ds_read_b64_tr_b16 v[220:221], v20 offset:32768
    ds_read_b64_tr_b16 v[224:225], v21 offset:32768
    v_mfma_f32_16x16x32_bf16 v[76:79], a[120:123], a[176:179], v[40:43]
    v_exp_f32 v84, v84
    v_mfma_f32_16x16x32_bf16 v[76:79], a[124:127], a[180:183], v[76:79]
    buffer_load_dwordx4 v25, s[12:15], s42 offen offset:3072 lds
    v_mfma_f32_16x16x32_bf16 v[76:79], a[128:131], a[184:187], v[76:79]
    s_bfe_u32 s43, s98, 0x3001c
    v_exp_f32 v85, v85
    v_mfma_f32_16x16x32_bf16 v[76:79], a[132:135], a[188:191], v[76:79]
    s_lshl_b32 s43, s43, 13
    s_waitcnt vmcnt(24)
    ds_read_b64_tr_b16 v[198:199], v14 offset:36864
    v_cvt_pk_bf16_f32 v96, v84, v85
    v_mfma_f32_16x16x32_bf16 v[80:83], a[136:139], a[176:179], v[40:43]
    s_add_u32 m0, s37, 98304
    v_exp_f32 v86, v86
    v_mfma_f32_16x16x32_bf16 v[80:83], a[140:143], a[180:183], v[80:83]
    s_waitcnt lgkmcnt(1)
    buffer_load_dwordx4 v26, s[16:19], s43 offen offset:0 lds
    v_mfma_f32_16x16x32_bf16 v[80:83], a[144:147], a[184:187], v[80:83]
    v_exp_f32 v87, v87
    v_mfma_f32_16x16x32_bf16 v[80:83], a[148:151], a[188:191], v[80:83]
    ds_read_b64_tr_b16 v[202:203], v15 offset:36864
    v_cvt_pk_bf16_f32 v97, v86, v87
    v_mfma_f32_16x16x32_bf16 a[152:155], v[32:35], v[92:95], a[152:155]
    v_exp_f32 v88, v88
    v_mfma_f32_16x16x32_bf16 v[56:59], v[164:167], v[92:95], v[56:59]
    buffer_load_dwordx4 v27, s[16:19], s43 offen offset:1024 lds
    v_mfma_f32_16x16x32_bf16 v[60:63], v[168:171], v[92:95], v[60:63]
    v_exp_f32 v89, v89
    v_mfma_f32_16x16x32_bf16 a[96:99], v[172:175], v[92:95], a[96:99]
    ds_read_b64_tr_b16 v[206:207], v16 offset:36864
    v_cvt_pk_bf16_f32 v98, v88, v89
    v_mfma_f32_16x16x32_bf16 a[100:103], v[176:179], v[92:95], a[100:103]
    v_exp_f32 v90, v90
    v_mfma_f32_16x16x32_bf16 a[104:107], v[180:183], v[92:95], a[104:107]
    buffer_load_dwordx4 v26, s[16:19], s43 offen offset:2048 lds
    v_mfma_f32_16x16x32_bf16 a[108:111], v[184:187], v[92:95], a[108:111]
    v_exp_f32 v91, v91
    v_mfma_f32_16x16x32_bf16 a[112:115], v[188:191], v[92:95], a[112:115]
    ds_read_b64_tr_b16 v[210:211], v17 offset:36864
    v_cvt_pk_bf16_f32 v99, v90, v91
    v_mfma_f32_16x16x32_bf16 a[116:119], v[192:195], v[92:95], a[116:119]
    ds_read_b64_tr_b16 v[214:215], v18 offset:36864
    ds_read_b64_tr_b16 v[218:219], v19 offset:36864
    v_mfma_f32_16x16x32_bf16 v[84:87], a[120:123], a[192:195], v[44:47]
    v_exp_f32 v76, v76
    v_mfma_f32_16x16x32_bf16 v[84:87], a[124:127], a[196:199], v[84:87]
    ds_read_b64_tr_b16 v[222:223], v20 offset:36864
    v_mfma_f32_16x16x32_bf16 v[84:87], a[128:131], a[200:203], v[84:87]
    v_exp_f32 v77, v77
    v_mfma_f32_16x16x32_bf16 v[84:87], a[132:135], a[204:207], v[84:87]
    ds_read_b64_tr_b16 v[226:227], v21 offset:36864
    v_cvt_pk_bf16_f32 v92, v76, v77
    v_mfma_f32_16x16x32_bf16 v[88:91], a[136:139], a[192:195], v[44:47]
    v_exp_f32 v78, v78
    v_mfma_f32_16x16x32_bf16 v[88:91], a[140:143], a[196:199], v[88:91]
    buffer_load_dwordx4 v27, s[16:19], s43 offen offset:3072 lds
    v_mfma_f32_16x16x32_bf16 v[88:91], a[144:147], a[200:203], v[88:91]
    v_exp_f32 v79, v79
    v_mfma_f32_16x16x32_bf16 v[88:91], a[148:151], a[204:207], v[88:91]
    s_add_u32 s43, s43, 4096
    v_cvt_pk_bf16_f32 v93, v78, v79
    v_mfma_f32_16x16x32_bf16 a[240:243], v[32:35], v[96:99], a[240:243]
    s_add_u32 m0, s37, 102400
    v_exp_f32 v80, v80
    s_waitcnt lgkmcnt(2)
    v_mfma_f32_16x16x32_bf16 v[132:135], v[196:199], v[96:99], v[132:135]
    s_waitcnt lgkmcnt(0)
    buffer_load_dwordx4 v26, s[16:19], s43 offen offset:0 lds
    v_mfma_f32_16x16x32_bf16 v[136:139], v[200:203], v[96:99], v[136:139]
    v_exp_f32 v81, v81
    v_mfma_f32_16x16x32_bf16 a[0:3], v[204:207], v[96:99], a[0:3]
    v_cvt_pk_bf16_f32 v94, v80, v81
    v_mfma_f32_16x16x32_bf16 a[4:7], v[208:211], v[96:99], a[4:7]
    v_exp_f32 v82, v82
    v_mfma_f32_16x16x32_bf16 a[8:11], v[212:215], v[96:99], a[8:11]
    buffer_load_dwordx4 v27, s[16:19], s43 offen offset:1024 lds
    v_mfma_f32_16x16x32_bf16 a[12:15], v[216:219], v[96:99], a[12:15]
    v_exp_f32 v83, v83
    v_mfma_f32_16x16x32_bf16 a[16:19], v[220:223], v[96:99], a[16:19]
    v_cvt_pk_bf16_f32 v95, v82, v83
    v_mfma_f32_16x16x32_bf16 a[20:23], v[224:227], v[96:99], a[20:23]
    buffer_load_dwordx4 v26, s[16:19], s43 offen offset:2048 lds
    v_mfma_f32_16x16x32_bf16 v[76:79], a[120:123], a[208:211], v[48:51]
    v_exp_f32 v84, v84
    v_mfma_f32_16x16x32_bf16 v[76:79], a[124:127], a[212:215], v[76:79]
    buffer_load_dwordx4 v27, s[16:19], s43 offen offset:3072 lds
    v_mfma_f32_16x16x32_bf16 v[76:79], a[128:131], a[216:219], v[76:79]
    v_exp_f32 v85, v85
    v_mfma_f32_16x16x32_bf16 v[76:79], a[132:135], a[220:223], v[76:79]
    s_waitcnt vmcnt(28)
    ds_read_b128 v[100:103], v10 offset:0
    v_cvt_pk_bf16_f32 v96, v84, v85
    v_mfma_f32_16x16x32_bf16 v[80:83], a[136:139], a[208:211], v[48:51]
    v_exp_f32 v86, v86
    v_mfma_f32_16x16x32_bf16 v[80:83], a[140:143], a[212:215], v[80:83]
    ds_read_b128 v[104:107], v11 offset:0
    v_mfma_f32_16x16x32_bf16 v[80:83], a[144:147], a[216:219], v[80:83]
    v_exp_f32 v87, v87
    v_mfma_f32_16x16x32_bf16 v[80:83], a[148:151], a[220:223], v[80:83]
    buffer_load_dword v65, v64, s[24:27], 0 offen offset:0
    v_cvt_pk_bf16_f32 v97, v86, v87
    v_mfma_f32_16x16x32_bf16 a[244:247], v[32:35], v[92:95], a[244:247]
    v_exp_f32 v88, v88
    v_mfma_f32_16x16x32_bf16 v[140:143], v[196:199], v[92:95], v[140:143]
    ds_read_b128 v[108:111], v12 offset:0
    v_mfma_f32_16x16x32_bf16 v[144:147], v[200:203], v[92:95], v[144:147]
    v_exp_f32 v89, v89
    v_mfma_f32_16x16x32_bf16 a[24:27], v[204:207], v[92:95], a[24:27]
    ds_read_b128 v[112:115], v13 offset:0
    v_cvt_pk_bf16_f32 v98, v88, v89
    v_mfma_f32_16x16x32_bf16 a[28:31], v[208:211], v[92:95], a[28:31]
    v_exp_f32 v90, v90
    v_mfma_f32_16x16x32_bf16 a[32:35], v[212:215], v[92:95], a[32:35]
    buffer_load_dword v72, v9, s[56:59], s100 offen offset:0 sc1
    v_mfma_f32_16x16x32_bf16 a[36:39], v[216:219], v[92:95], a[36:39]
    v_exp_f32 v91, v91
    v_mfma_f32_16x16x32_bf16 a[40:43], v[220:223], v[92:95], a[40:43]
    s_waitcnt vmcnt(22)
    ds_read_b64_tr_b16 v[164:165], v14 offset:0
    v_cvt_pk_bf16_f32 v99, v90, v91
    v_mfma_f32_16x16x32_bf16 a[44:47], v[224:227], v[92:95], a[44:47]
    ds_read_b64_tr_b16 v[168:169], v15 offset:0
    v_mfma_f32_16x16x32_bf16 v[84:87], a[120:123], a[224:227], v[52:55]
    v_exp_f32 v76, v76
    v_mfma_f32_16x16x32_bf16 v[84:87], a[124:127], a[228:231], v[84:87]
    ds_read_b128 v[116:119], v10 offset:4096
    v_mfma_f32_16x16x32_bf16 v[84:87], a[128:131], a[232:235], v[84:87]
    v_exp_f32 v77, v77
    v_mfma_f32_16x16x32_bf16 v[84:87], a[132:135], a[236:239], v[84:87]
    ds_read_b128 v[120:123], v11 offset:4096
    v_cvt_pk_bf16_f32 v92, v76, v77
    v_mfma_f32_16x16x32_bf16 v[88:91], a[136:139], a[224:227], v[52:55]
    v_exp_f32 v78, v78
    v_mfma_f32_16x16x32_bf16 v[88:91], a[140:143], a[228:231], v[88:91]
    ds_read_b128 v[124:127], v12 offset:4096
    v_mfma_f32_16x16x32_bf16 v[88:91], a[144:147], a[232:235], v[88:91]
    v_exp_f32 v79, v79
    v_mfma_f32_16x16x32_bf16 v[88:91], a[148:151], a[236:239], v[88:91]
    ds_read_b128 v[128:131], v13 offset:4096
    v_cvt_pk_bf16_f32 v93, v78, v79
    v_mfma_f32_16x16x32_bf16 a[248:251], v[32:35], v[96:99], a[248:251]
    v_exp_f32 v80, v80
    v_mfma_f32_16x16x32_bf16 v[148:151], v[196:199], v[96:99], v[148:151]
    s_waitcnt vmcnt(14)
    ds_read_b128 a[120:123], v10 offset:32768
    v_mfma_f32_16x16x32_bf16 v[152:155], v[200:203], v[96:99], v[152:155]
    v_exp_f32 v81, v81
    v_mfma_f32_16x16x32_bf16 a[48:51], v[204:207], v[96:99], a[48:51]
    ds_read_b128 a[124:127], v11 offset:32768
    v_cvt_pk_bf16_f32 v94, v80, v81
    v_mfma_f32_16x16x32_bf16 a[52:55], v[208:211], v[96:99], a[52:55]
    v_exp_f32 v82, v82
    v_mfma_f32_16x16x32_bf16 a[56:59], v[212:215], v[96:99], a[56:59]
    buffer_load_dword v73, v9, s[56:59], s101 offen offset:0 sc1
    ds_read_b128 a[128:131], v12 offset:32768
    v_mfma_f32_16x16x32_bf16 a[60:63], v[216:219], v[96:99], a[60:63]
    v_exp_f32 v83, v83
    v_mfma_f32_16x16x32_bf16 a[64:67], v[220:223], v[96:99], a[64:67]
    ds_read_b128 a[132:135], v13 offset:32768
    v_cvt_pk_bf16_f32 v95, v82, v83
    v_mfma_f32_16x16x32_bf16 a[68:71], v[224:227], v[96:99], a[68:71]
    s_waitcnt vmcnt(11)
    ds_read_b128 a[136:139], v10 offset:36864
    s_waitcnt lgkmcnt(11)
    v_mfma_f32_16x16x32_bf16 v[76:79], v[100:103], a[160:163], v[36:39]
    v_exp_f32 v84, v84
    v_mfma_f32_16x16x32_bf16 v[76:79], v[104:107], a[164:167], v[76:79]
    ds_read_b128 a[140:143], v11 offset:36864
    v_mfma_f32_16x16x32_bf16 v[76:79], v[108:111], a[168:171], v[76:79]
    v_exp_f32 v85, v85
    v_mfma_f32_16x16x32_bf16 v[76:79], v[112:115], a[172:175], v[76:79]
    s_waitcnt lgkmcnt(6)
    ds_read_b128 a[144:147], v12 offset:36864
    v_cvt_pk_bf16_f32 v96, v84, v85
    v_mfma_f32_16x16x32_bf16 v[80:83], v[116:119], a[160:163], v[36:39]
    v_exp_f32 v86, v86
    v_mfma_f32_16x16x32_bf16 v[80:83], v[120:123], a[164:167], v[80:83]
    ds_read_b128 a[148:151], v13 offset:36864
    v_mfma_f32_16x16x32_bf16 v[80:83], v[124:127], a[168:171], v[80:83]
    v_exp_f32 v87, v87
    v_mfma_f32_16x16x32_bf16 v[80:83], v[128:131], a[172:175], v[80:83]
    ds_read_b64_tr_b16 v[172:173], v16 offset:0
    v_cvt_pk_bf16_f32 v97, v86, v87
    v_mfma_f32_16x16x32_bf16 a[252:255], v[32:35], v[92:95], a[252:255]
    v_exp_f32 v88, v88
    v_mfma_f32_16x16x32_bf16 v[156:159], v[196:199], v[92:95], v[156:159]
    ds_read_b64_tr_b16 v[176:177], v17 offset:0
    v_mfma_f32_16x16x32_bf16 v[160:163], v[200:203], v[92:95], v[160:163]
    v_exp_f32 v89, v89
    v_mfma_f32_16x16x32_bf16 a[72:75], v[204:207], v[92:95], a[72:75]
    ds_read_b64_tr_b16 v[180:181], v18 offset:0
    v_cvt_pk_bf16_f32 v98, v88, v89
    v_mfma_f32_16x16x32_bf16 a[76:79], v[208:211], v[92:95], a[76:79]
    v_exp_f32 v90, v90
    v_mfma_f32_16x16x32_bf16 a[80:83], v[212:215], v[92:95], a[80:83]
    ds_read_b64_tr_b16 v[184:185], v19 offset:0
    v_mfma_f32_16x16x32_bf16 a[84:87], v[216:219], v[92:95], a[84:87]
    v_exp_f32 v91, v91
    v_mfma_f32_16x16x32_bf16 a[88:91], v[220:223], v[92:95], a[88:91]
    ds_read_b64_tr_b16 v[188:189], v20 offset:0
    v_cvt_pk_bf16_f32 v99, v90, v91
    v_mfma_f32_16x16x32_bf16 a[92:95], v[224:227], v[92:95], a[92:95]
    s_waitcnt lgkmcnt(9)
    ds_read_b64_tr_b16 v[192:193], v21 offset:0
    v_mfma_f32_16x16x32_bf16 v[84:87], a[120:123], a[160:163], v[36:39]
    v_exp_f32 v76, v76
    v_mfma_f32_16x16x32_bf16 v[84:87], a[124:127], a[164:167], v[84:87]
    ds_read_b64_tr_b16 v[166:167], v14 offset:4096
    v_mfma_f32_16x16x32_bf16 v[84:87], a[128:131], a[168:171], v[84:87]
    v_exp_f32 v77, v77
    v_mfma_f32_16x16x32_bf16 v[84:87], a[132:135], a[172:175], v[84:87]
    s_waitcnt lgkmcnt(7)
    ds_read_b64_tr_b16 v[170:171], v15 offset:4096
    v_cvt_pk_bf16_f32 v92, v76, v77
    v_mfma_f32_16x16x32_bf16 v[88:91], a[136:139], a[160:163], v[36:39]
    v_exp_f32 v78, v78
    v_mfma_f32_16x16x32_bf16 v[88:91], a[140:143], a[164:167], v[88:91]
    ds_read_b64_tr_b16 v[174:175], v16 offset:4096
    v_mfma_f32_16x16x32_bf16 v[88:91], a[144:147], a[168:171], v[88:91]
    v_exp_f32 v79, v79
    v_mfma_f32_16x16x32_bf16 v[88:91], a[148:151], a[172:175], v[88:91]
    ds_read_b64_tr_b16 v[178:179], v17 offset:4096
    v_cvt_pk_bf16_f32 v93, v78, v79
    v_mfma_f32_16x16x32_bf16 a[152:155], v[32:35], v[96:99], a[152:155]
    v_exp_f32 v80, v80
    v_mfma_f32_16x16x32_bf16 v[56:59], v[196:199], v[96:99], v[56:59]
    ds_read_b64_tr_b16 v[182:183], v18 offset:4096
    v_mfma_f32_16x16x32_bf16 v[60:63], v[200:203], v[96:99], v[60:63]
    v_exp_f32 v81, v81
    v_mfma_f32_16x16x32_bf16 a[96:99], v[204:207], v[96:99], a[96:99]
    ds_read_b64_tr_b16 v[186:187], v19 offset:4096
    v_cvt_pk_bf16_f32 v94, v80, v81
    v_mfma_f32_16x16x32_bf16 a[100:103], v[208:211], v[96:99], a[100:103]
    v_exp_f32 v82, v82
    v_mfma_f32_16x16x32_bf16 a[104:107], v[212:215], v[96:99], a[104:107]
    ds_read_b64_tr_b16 v[190:191], v20 offset:4096
    v_mfma_f32_16x16x32_bf16 a[108:111], v[216:219], v[96:99], a[108:111]
    v_exp_f32 v83, v83
    v_mfma_f32_16x16x32_bf16 a[112:115], v[220:223], v[96:99], a[112:115]
    ds_read_b64_tr_b16 v[194:195], v21 offset:4096
    v_cvt_pk_bf16_f32 v95, v82, v83
    v_mfma_f32_16x16x32_bf16 a[116:119], v[224:227], v[96:99], a[116:119]
    s_waitcnt vmcnt(7)
    ds_read_b64_tr_b16 v[196:197], v14 offset:32768
    s_waitcnt vmcnt(3)
    ds_read_b64_tr_b16 v[198:199], v14 offset:36864
    v_mfma_f32_16x16x32_bf16 v[76:79], v[100:103], a[176:179], v[40:43]
    v_exp_f32 v84, v84
    v_mfma_f32_16x16x32_bf16 v[76:79], v[104:107], a[180:183], v[76:79]
    ds_read_b64_tr_b16 v[200:201], v15 offset:32768
    v_mfma_f32_16x16x32_bf16 v[76:79], v[108:111], a[184:187], v[76:79]
    v_exp_f32 v85, v85
    v_mfma_f32_16x16x32_bf16 v[76:79], v[112:115], a[188:191], v[76:79]
    ds_read_b64_tr_b16 v[202:203], v15 offset:36864
    v_cvt_pk_bf16_f32 v96, v84, v85
    v_mfma_f32_16x16x32_bf16 v[80:83], v[116:119], a[176:179], v[40:43]
    v_exp_f32 v86, v86
    v_mfma_f32_16x16x32_bf16 v[80:83], v[120:123], a[180:183], v[80:83]
    ds_read_b64_tr_b16 v[204:205], v16 offset:32768
    v_mfma_f32_16x16x32_bf16 v[80:83], v[124:127], a[184:187], v[80:83]
    v_exp_f32 v87, v87
    v_mfma_f32_16x16x32_bf16 v[80:83], v[128:131], a[188:191], v[80:83]
    ds_read_b64_tr_b16 v[206:207], v16 offset:36864
    v_cvt_pk_bf16_f32 v97, v86, v87
    v_mfma_f32_16x16x32_bf16 a[240:243], v[32:35], v[92:95], a[240:243]
    s_waitcnt lgkmcnt(8)
    v_exp_f32 v88, v88
    v_mfma_f32_16x16x32_bf16 v[132:135], v[164:167], v[92:95], v[132:135]
    ds_read_b64_tr_b16 v[208:209], v17 offset:32768
    v_mfma_f32_16x16x32_bf16 v[136:139], v[168:171], v[92:95], v[136:139]
    v_exp_f32 v89, v89
    v_mfma_f32_16x16x32_bf16 a[0:3], v[172:175], v[92:95], a[0:3]
    ds_read_b64_tr_b16 v[210:211], v17 offset:36864
    v_cvt_pk_bf16_f32 v98, v88, v89
    v_mfma_f32_16x16x32_bf16 a[4:7], v[176:179], v[92:95], a[4:7]
    v_exp_f32 v90, v90
    v_mfma_f32_16x16x32_bf16 a[8:11], v[180:183], v[92:95], a[8:11]
    s_waitcnt lgkmcnt(8)
    ds_read_b64_tr_b16 v[212:213], v18 offset:32768
    v_mfma_f32_16x16x32_bf16 a[12:15], v[184:187], v[92:95], a[12:15]
    v_exp_f32 v91, v91
    v_mfma_f32_16x16x32_bf16 a[16:19], v[188:191], v[92:95], a[16:19]
    ds_read_b64_tr_b16 v[214:215], v18 offset:36864
    v_cvt_pk_bf16_f32 v99, v90, v91
    v_mfma_f32_16x16x32_bf16 a[20:23], v[192:195], v[92:95], a[20:23]
    ds_read_b64_tr_b16 v[216:217], v19 offset:32768
    ds_read_b64_tr_b16 v[218:219], v19 offset:36864
    s_barrier
    v_mfma_f32_16x16x32_bf16 v[84:87], a[120:123], a[176:179], v[40:43]
    v_exp_f32 v76, v76
    v_mfma_f32_16x16x32_bf16 v[84:87], a[124:127], a[180:183], v[84:87]
    ds_read_b64_tr_b16 v[220:221], v20 offset:32768
    v_mfma_f32_16x16x32_bf16 v[84:87], a[128:131], a[184:187], v[84:87]
    v_exp_f32 v77, v77
    v_mfma_f32_16x16x32_bf16 v[84:87], a[132:135], a[188:191], v[84:87]
    ds_read_b64_tr_b16 v[222:223], v20 offset:36864
    v_cvt_pk_bf16_f32 v92, v76, v77
    v_mfma_f32_16x16x32_bf16 v[88:91], a[136:139], a[176:179], v[40:43]
    v_exp_f32 v78, v78
    v_mfma_f32_16x16x32_bf16 v[88:91], a[140:143], a[180:183], v[88:91]
    ds_read_b64_tr_b16 v[224:225], v21 offset:32768
    v_mfma_f32_16x16x32_bf16 v[88:91], a[144:147], a[184:187], v[88:91]
    v_exp_f32 v79, v79
    v_mfma_f32_16x16x32_bf16 v[88:91], a[148:151], a[188:191], v[88:91]
    ds_read_b64_tr_b16 v[226:227], v21 offset:36864
    v_cvt_pk_bf16_f32 v93, v78, v79
    v_mfma_f32_16x16x32_bf16 a[240:243], v[32:35], v[96:99], a[240:243]
    s_waitcnt lgkmcnt(4)
    v_exp_f32 v80, v80
    v_mfma_f32_16x16x32_bf16 v[132:135], v[196:199], v[96:99], v[132:135]
    v_mfma_f32_16x16x32_bf16 v[136:139], v[200:203], v[96:99], v[136:139]
    v_exp_f32 v81, v81
    v_mfma_f32_16x16x32_bf16 a[0:3], v[204:207], v[96:99], a[0:3]
    v_cvt_pk_bf16_f32 v94, v80, v81
    v_mfma_f32_16x16x32_bf16 a[4:7], v[208:211], v[96:99], a[4:7]
    v_exp_f32 v82, v82
    v_mfma_f32_16x16x32_bf16 a[8:11], v[212:215], v[96:99], a[8:11]
    s_waitcnt lgkmcnt(0)
    v_mfma_f32_16x16x32_bf16 a[12:15], v[216:219], v[96:99], a[12:15]
    v_exp_f32 v83, v83
    v_mfma_f32_16x16x32_bf16 a[16:19], v[220:223], v[96:99], a[16:19]
    v_cvt_pk_bf16_f32 v95, v82, v83
    v_mfma_f32_16x16x32_bf16 a[20:23], v[224:227], v[96:99], a[20:23]
    v_mfma_f32_16x16x32_bf16 v[76:79], v[100:103], a[192:195], v[44:47]
    v_exp_f32 v84, v84
    v_mfma_f32_16x16x32_bf16 v[76:79], v[104:107], a[196:199], v[76:79]
    ds_write_b128 v29, a[0:3] offset:0
    v_mfma_f32_16x16x32_bf16 v[76:79], v[108:111], a[200:203], v[76:79]
    s_lshl_b32 s42, s69, 17
    v_exp_f32 v85, v85
    v_mfma_f32_16x16x32_bf16 v[76:79], v[112:115], a[204:207], v[76:79]
    s_add_u32 s38, s42, 0
    v_cvt_pk_bf16_f32 v96, v84, v85
    v_mfma_f32_16x16x32_bf16 v[80:83], v[116:119], a[192:195], v[44:47]
    s_add_u32 m0, s36, 131072
    v_exp_f32 v86, v86
    v_mfma_f32_16x16x32_bf16 v[80:83], v[120:123], a[196:199], v[80:83]
    buffer_load_dwordx4 v235, s[24:27], s38 offen offset:0 lds
    v_mfma_f32_16x16x32_bf16 v[80:83], v[124:127], a[200:203], v[80:83]
    v_exp_f32 v87, v87
    v_mfma_f32_16x16x32_bf16 v[80:83], v[128:131], a[204:207], v[80:83]
    ds_write_b32 v31, a240 offset:0
    v_cvt_pk_bf16_f32 v97, v86, v87
    v_mfma_f32_16x16x32_bf16 a[244:247], v[32:35], v[92:95], a[244:247]
    v_exp_f32 v88, v88
    v_mfma_f32_16x16x32_bf16 v[140:143], v[164:167], v[92:95], v[140:143]
    ds_write_b128 v29, a[4:7] offset:1024
    v_mfma_f32_16x16x32_bf16 v[144:147], v[168:171], v[92:95], v[144:147]
    v_exp_f32 v89, v89
    v_mfma_f32_16x16x32_bf16 a[24:27], v[172:175], v[92:95], a[24:27]
    v_cvt_pk_bf16_f32 v98, v88, v89
    v_mfma_f32_16x16x32_bf16 a[28:31], v[176:179], v[92:95], a[28:31]
    v_exp_f32 v90, v90
    v_mfma_f32_16x16x32_bf16 a[32:35], v[180:183], v[92:95], a[32:35]
    ds_write_b128 v29, a[8:11] offset:2048
    v_mfma_f32_16x16x32_bf16 a[36:39], v[184:187], v[92:95], a[36:39]
    s_add_u32 s38, s42, 16384
    v_exp_f32 v91, v91
    v_mfma_f32_16x16x32_bf16 a[40:43], v[188:191], v[92:95], a[40:43]
    s_add_u32 m0, s36, 135168
    v_cvt_pk_bf16_f32 v99, v90, v91
    v_mfma_f32_16x16x32_bf16 a[44:47], v[192:195], v[92:95], a[44:47]
    buffer_load_dwordx4 v235, s[24:27], s38 offen offset:0 lds
    v_mfma_f32_16x16x32_bf16 v[84:87], a[120:123], a[192:195], v[44:47]
    v_exp_f32 v76, v76
    v_mfma_f32_16x16x32_bf16 v[84:87], a[124:127], a[196:199], v[84:87]
    ds_write_b128 v29, a[12:15] offset:3072
    v_mfma_f32_16x16x32_bf16 v[84:87], a[128:131], a[200:203], v[84:87]
    v_exp_f32 v77, v77
    v_mfma_f32_16x16x32_bf16 v[84:87], a[132:135], a[204:207], v[84:87]
    s_add_u32 s38, s42, 32768
    v_cvt_pk_bf16_f32 v92, v76, v77
    v_mfma_f32_16x16x32_bf16 v[88:91], a[136:139], a[192:195], v[44:47]
    s_add_u32 m0, s36, 139264
    v_exp_f32 v78, v78
    v_mfma_f32_16x16x32_bf16 v[88:91], a[140:143], a[196:199], v[88:91]
    buffer_load_dwordx4 v235, s[24:27], s38 offen offset:0 lds
    v_mfma_f32_16x16x32_bf16 v[88:91], a[144:147], a[200:203], v[88:91]
    v_exp_f32 v79, v79
    v_mfma_f32_16x16x32_bf16 v[88:91], a[148:151], a[204:207], v[88:91]
    v_cvt_pk_bf16_f32 v93, v78, v79
    v_mfma_f32_16x16x32_bf16 a[244:247], v[32:35], v[96:99], a[244:247]
    v_exp_f32 v80, v80
    v_mfma_f32_16x16x32_bf16 v[140:143], v[196:199], v[96:99], v[140:143]
    ds_write_b128 v29, a[16:19] offset:4096
    v_mfma_f32_16x16x32_bf16 v[144:147], v[200:203], v[96:99], v[144:147]
    v_exp_f32 v81, v81
    v_mfma_f32_16x16x32_bf16 a[24:27], v[204:207], v[96:99], a[24:27]
    v_cvt_pk_bf16_f32 v94, v80, v81
    v_mfma_f32_16x16x32_bf16 a[28:31], v[208:211], v[96:99], a[28:31]
    v_exp_f32 v82, v82
    v_mfma_f32_16x16x32_bf16 a[32:35], v[212:215], v[96:99], a[32:35]
    ds_write_b128 v29, a[20:23] offset:5120
    v_mfma_f32_16x16x32_bf16 a[36:39], v[216:219], v[96:99], a[36:39]
    s_add_u32 s38, s42, 49152
    v_exp_f32 v83, v83
    v_mfma_f32_16x16x32_bf16 a[40:43], v[220:223], v[96:99], a[40:43]
    s_add_u32 m0, s36, 143360
    v_cvt_pk_bf16_f32 v95, v82, v83
    v_mfma_f32_16x16x32_bf16 a[44:47], v[224:227], v[96:99], a[44:47]
    buffer_load_dwordx4 v235, s[24:27], s38 offen offset:0 lds
    v_mfma_f32_16x16x32_bf16 v[76:79], v[100:103], a[208:211], v[48:51]
    v_exp_f32 v84, v84
    v_mfma_f32_16x16x32_bf16 v[76:79], v[104:107], a[212:215], v[76:79]
    ds_write_b128 v29, a[24:27] offset:6144
    v_mfma_f32_16x16x32_bf16 v[76:79], v[108:111], a[216:219], v[76:79]
    v_exp_f32 v85, v85
    v_mfma_f32_16x16x32_bf16 v[76:79], v[112:115], a[220:223], v[76:79]
    s_add_u32 s38, s42, 65536
    v_cvt_pk_bf16_f32 v96, v84, v85
    v_mfma_f32_16x16x32_bf16 v[80:83], v[116:119], a[208:211], v[48:51]
    s_add_u32 m0, s36, 147456
    v_exp_f32 v86, v86
    v_mfma_f32_16x16x32_bf16 v[80:83], v[120:123], a[212:215], v[80:83]
    buffer_load_dwordx4 v235, s[24:27], s38 offen offset:0 lds
    v_mfma_f32_16x16x32_bf16 v[80:83], v[124:127], a[216:219], v[80:83]
    v_exp_f32 v87, v87
    v_mfma_f32_16x16x32_bf16 v[80:83], v[128:131], a[220:223], v[80:83]
    ds_write_b32 v31, a244 offset:4
    v_cvt_pk_bf16_f32 v97, v86, v87
    v_mfma_f32_16x16x32_bf16 a[248:251], v[32:35], v[92:95], a[248:251]
    v_exp_f32 v88, v88
    v_mfma_f32_16x16x32_bf16 v[148:151], v[164:167], v[92:95], v[148:151]
    ds_write_b128 v29, a[28:31] offset:7168
    v_mfma_f32_16x16x32_bf16 v[152:155], v[168:171], v[92:95], v[152:155]
    v_exp_f32 v89, v89
    v_mfma_f32_16x16x32_bf16 a[48:51], v[172:175], v[92:95], a[48:51]
    v_cvt_pk_bf16_f32 v98, v88, v89
    v_mfma_f32_16x16x32_bf16 a[52:55], v[176:179], v[92:95], a[52:55]
    v_exp_f32 v90, v90
    v_mfma_f32_16x16x32_bf16 a[56:59], v[180:183], v[92:95], a[56:59]
    ds_write_b128 v29, a[32:35] offset:32768
    v_mfma_f32_16x16x32_bf16 a[60:63], v[184:187], v[92:95], a[60:63]
    s_add_u32 s38, s42, 81920
    v_exp_f32 v91, v91
    v_mfma_f32_16x16x32_bf16 a[64:67], v[188:191], v[92:95], a[64:67]
    s_add_u32 m0, s36, 151552
    v_cvt_pk_bf16_f32 v99, v90, v91
    v_mfma_f32_16x16x32_bf16 a[68:71], v[192:195], v[92:95], a[68:71]
    buffer_load_dwordx4 v235, s[24:27], s38 offen offset:0 lds
    v_mfma_f32_16x16x32_bf16 v[84:87], a[120:123], a[208:211], v[48:51]
    v_exp_f32 v76, v76
    v_mfma_f32_16x16x32_bf16 v[84:87], a[124:127], a[212:215], v[84:87]
    ds_write_b128 v29, a[36:39] offset:33792
    v_mfma_f32_16x16x32_bf16 v[84:87], a[128:131], a[216:219], v[84:87]
    v_exp_f32 v77, v77
    v_mfma_f32_16x16x32_bf16 v[84:87], a[132:135], a[220:223], v[84:87]
    s_add_u32 s38, s42, 98304
    v_cvt_pk_bf16_f32 v92, v76, v77
    v_mfma_f32_16x16x32_bf16 v[88:91], a[136:139], a[208:211], v[48:51]
    s_add_u32 m0, s36, 155648
    v_exp_f32 v78, v78
    v_mfma_f32_16x16x32_bf16 v[88:91], a[140:143], a[212:215], v[88:91]
    buffer_load_dwordx4 v235, s[24:27], s38 offen offset:0 lds
    v_mfma_f32_16x16x32_bf16 v[88:91], a[144:147], a[216:219], v[88:91]
    v_exp_f32 v79, v79
    v_mfma_f32_16x16x32_bf16 v[88:91], a[148:151], a[220:223], v[88:91]
    v_cvt_pk_bf16_f32 v93, v78, v79
    v_mfma_f32_16x16x32_bf16 a[248:251], v[32:35], v[96:99], a[248:251]
    v_exp_f32 v80, v80
    v_mfma_f32_16x16x32_bf16 v[148:151], v[196:199], v[96:99], v[148:151]
    ds_write_b128 v29, a[40:43] offset:34816
    v_mfma_f32_16x16x32_bf16 v[152:155], v[200:203], v[96:99], v[152:155]
    v_exp_f32 v81, v81
    v_mfma_f32_16x16x32_bf16 a[48:51], v[204:207], v[96:99], a[48:51]
    v_cvt_pk_bf16_f32 v94, v80, v81
    v_mfma_f32_16x16x32_bf16 a[52:55], v[208:211], v[96:99], a[52:55]
    v_exp_f32 v82, v82
    v_mfma_f32_16x16x32_bf16 a[56:59], v[212:215], v[96:99], a[56:59]
    ds_write_b128 v29, a[44:47] offset:35840
    v_mfma_f32_16x16x32_bf16 a[60:63], v[216:219], v[96:99], a[60:63]
    s_add_u32 s38, s42, 114688
    v_exp_f32 v83, v83
    v_mfma_f32_16x16x32_bf16 a[64:67], v[220:223], v[96:99], a[64:67]
    s_add_u32 m0, s36, 159744
    v_cvt_pk_bf16_f32 v95, v82, v83
    v_mfma_f32_16x16x32_bf16 a[68:71], v[224:227], v[96:99], a[68:71]
    buffer_load_dwordx4 v235, s[24:27], s38 offen offset:0 lds
    v_mfma_f32_16x16x32_bf16 v[76:79], v[100:103], a[224:227], v[52:55]
    v_exp_f32 v84, v84
    v_mfma_f32_16x16x32_bf16 v[76:79], v[104:107], a[228:231], v[76:79]
    ds_write_b128 v29, a[48:51] offset:36864
    v_mfma_f32_16x16x32_bf16 v[76:79], v[108:111], a[232:235], v[76:79]
    v_exp_f32 v85, v85
    v_mfma_f32_16x16x32_bf16 v[76:79], v[112:115], a[236:239], v[76:79]
    v_cvt_pk_bf16_f32 v96, v84, v85
    v_mfma_f32_16x16x32_bf16 v[80:83], v[116:119], a[224:227], v[52:55]
    v_exp_f32 v86, v86
    v_mfma_f32_16x16x32_bf16 v[80:83], v[120:123], a[228:231], v[80:83]
    v_mfma_f32_16x16x32_bf16 v[80:83], v[124:127], a[232:235], v[80:83]
    v_exp_f32 v87, v87
    v_mfma_f32_16x16x32_bf16 v[80:83], v[128:131], a[236:239], v[80:83]
    ds_write_b32 v31, a248 offset:16
    v_cvt_pk_bf16_f32 v97, v86, v87
    v_mfma_f32_16x16x32_bf16 a[252:255], v[32:35], v[92:95], a[252:255]
    v_exp_f32 v88, v88
    v_mfma_f32_16x16x32_bf16 v[156:159], v[164:167], v[92:95], v[156:159]
    ds_write_b128 v29, a[52:55] offset:37888
    v_mfma_f32_16x16x32_bf16 v[160:163], v[168:171], v[92:95], v[160:163]
    v_exp_f32 v89, v89
    v_mfma_f32_16x16x32_bf16 a[72:75], v[172:175], v[92:95], a[72:75]
    v_cvt_pk_bf16_f32 v98, v88, v89
    v_mfma_f32_16x16x32_bf16 a[76:79], v[176:179], v[92:95], a[76:79]
    v_exp_f32 v90, v90
    v_mfma_f32_16x16x32_bf16 a[80:83], v[180:183], v[92:95], a[80:83]
    ds_write_b128 v29, a[56:59] offset:38912
    v_mfma_f32_16x16x32_bf16 a[84:87], v[184:187], v[92:95], a[84:87]
    v_exp_f32 v91, v91
    v_mfma_f32_16x16x32_bf16 a[88:91], v[188:191], v[92:95], a[88:91]
    v_cvt_pk_bf16_f32 v99, v90, v91
    v_mfma_f32_16x16x32_bf16 a[92:95], v[192:195], v[92:95], a[92:95]
    s_waitcnt vmcnt(0) lgkmcnt(4)
    s_barrier
    v_mfma_f32_16x16x32_bf16 v[84:87], a[120:123], a[224:227], v[52:55]
    v_exp_f32 v76, v76
    v_mfma_f32_16x16x32_bf16 v[84:87], a[124:127], a[228:231], v[84:87]
    ds_write_b128 v29, a[60:63] offset:39936
    v_mfma_f32_16x16x32_bf16 v[84:87], a[128:131], a[232:235], v[84:87]
    v_exp_f32 v77, v77
    v_mfma_f32_16x16x32_bf16 v[84:87], a[132:135], a[236:239], v[84:87]
    ds_read_b64 v[124:125], v234 offset:0
    v_cvt_pk_bf16_f32 v92, v76, v77
    v_mfma_f32_16x16x32_bf16 v[88:91], a[136:139], a[224:227], v[52:55]
    v_exp_f32 v78, v78
    v_mfma_f32_16x16x32_bf16 v[88:91], a[140:143], a[228:231], v[88:91]
    ds_read_b64 v[126:127], v234 offset:8192
    ds_read_b64 v[128:129], v234 offset:16384
    v_mfma_f32_16x16x32_bf16 v[88:91], a[144:147], a[232:235], v[88:91]
    v_exp_f32 v79, v79
    v_mfma_f32_16x16x32_bf16 v[88:91], a[148:151], a[236:239], v[88:91]
    ds_read_b64 v[130:131], v234 offset:24576
    v_cvt_pk_bf16_f32 v93, v78, v79
    v_mfma_f32_16x16x32_bf16 a[252:255], v[32:35], v[96:99], a[252:255]
    v_exp_f32 v80, v80
    v_mfma_f32_16x16x32_bf16 v[156:159], v[196:199], v[96:99], v[156:159]
    ds_write_b128 v30, a[64:67] offset:0
    v_mfma_f32_16x16x32_bf16 v[160:163], v[200:203], v[96:99], v[160:163]
    v_exp_f32 v81, v81
    v_mfma_f32_16x16x32_bf16 a[72:75], v[204:207], v[96:99], a[72:75]
    ds_read_b128 v[36:39], v228 offset:0
    v_cvt_pk_bf16_f32 v94, v80, v81
    v_mfma_f32_16x16x32_bf16 a[76:79], v[208:211], v[96:99], a[76:79]
    v_exp_f32 v82, v82
    v_mfma_f32_16x16x32_bf16 a[80:83], v[212:215], v[96:99], a[80:83]
    ds_write_b128 v30, a[68:71] offset:1024
    v_mfma_f32_16x16x32_bf16 a[84:87], v[216:219], v[96:99], a[84:87]
    v_exp_f32 v83, v83
    v_mfma_f32_16x16x32_bf16 a[88:91], v[220:223], v[96:99], a[88:91]
    ds_read_b128 v[40:43], v228 offset:1024
    v_cvt_pk_bf16_f32 v95, v82, v83
    v_mfma_f32_16x16x32_bf16 a[92:95], v[224:227], v[96:99], a[92:95]
    ds_read_b128 v[44:47], v230 offset:2048
    ds_read_b128 v[48:51], v230 offset:3072
    v_mfma_f32_16x16x32_bf16 a[152:155], v[32:35], v[92:95], a[152:155]
    ds_write_b32 v31, a252 offset:20
    v_exp_f32 v84, v84
    v_mfma_f32_16x16x32_bf16 v[56:59], v[164:167], v[92:95], v[56:59]
    ds_read_b128 v[64:67], v232 offset:4096
    ds_read_b128 v[68:71], v232 offset:5120
    v_exp_f32 v85, v85
    v_mfma_f32_16x16x32_bf16 v[60:63], v[168:171], v[92:95], v[60:63]
    ds_write_b128 v30, a[72:75] offset:2048
    v_exp_f32 v86, v86
    v_cvt_pk_bf16_f32 v96, v84, v85
    v_mfma_f32_16x16x32_bf16 a[96:99], v[172:175], v[92:95], a[96:99]
    ds_read_b128 v[100:103], v228 offset:6144
    ds_read_b128 v[104:107], v228 offset:7168
    v_exp_f32 v87, v87
    v_mfma_f32_16x16x32_bf16 a[100:103], v[176:179], v[92:95], a[100:103]
    ds_write_b128 v30, a[76:79] offset:3072
    v_exp_f32 v88, v88
    v_cvt_pk_bf16_f32 v97, v86, v87
    v_mfma_f32_16x16x32_bf16 a[104:107], v[180:183], v[92:95], a[104:107]
    ds_read_b128 v[108:111], v230 offset:32768
    ds_read_b128 v[112:115], v230 offset:33792
    v_exp_f32 v89, v89
    v_mfma_f32_16x16x32_bf16 a[108:111], v[184:187], v[92:95], a[108:111]
    ds_write_b128 v30, a[80:83] offset:4096
    v_exp_f32 v90, v90
    v_cvt_pk_bf16_f32 v98, v88, v89
    v_mfma_f32_16x16x32_bf16 a[112:115], v[188:191], v[92:95], a[112:115]
    ds_read_b128 v[116:119], v232 offset:34816
    ds_read_b128 v[120:123], v232 offset:35840
    v_exp_f32 v91, v91
    v_mfma_f32_16x16x32_bf16 a[116:119], v[192:195], v[92:95], a[116:119]
    v_cvt_pk_bf16_f32 v99, v90, v91
    s_nop 1
    v_mfma_f32_16x16x32_bf16 a[152:155], v[32:35], v[96:99], a[152:155]
    s_waitcnt lgkmcnt(14)
    ds_write_b128 v30, a[84:87] offset:5120
    v_add_f32 v4, v124, v126
    v_mfma_f32_16x16x32_bf16 v[56:59], v[196:199], v[96:99], v[56:59]
    v_add_f32 v128, v128, v130
    v_add_f32 v4, v4, v128
    v_mfma_f32_16x16x32_bf16 v[60:63], v[200:203], v[96:99], v[60:63]
    v_add_f32 v5, v125, v127
    v_add_f32 v129, v129, v131
    v_mfma_f32_16x16x32_bf16 a[96:99], v[204:207], v[96:99], a[96:99]
    ds_write_b128 v30, a[88:91] offset:6144
    v_add_f32 v5, v5, v129
    v_mfma_f32_16x16x32_bf16 a[100:103], v[208:211], v[96:99], a[100:103]
    v_min3_f32 v124, v4, v5, v5
    v_add_f32 v125, v4, v5
    v_mfma_f32_16x16x32_bf16 a[104:107], v[212:215], v[96:99], a[104:107]
    v_cmp_nle_f32 vcc, 0x2b800000, v124
    s_nop 1
    s_mov_b64 s[74:75], vcc
    v_cmp_nge_f32 vcc, 0x53800000, v125
    s_nop 1
    s_or_b64 vcc, vcc, s[74:75]
    s_and_b64 vcc, vcc, s[70:71]
    s_cbranch_vccnz L_redo
    v_mfma_f32_16x16x32_bf16 a[108:111], v[216:219], v[96:99], a[108:111]
    ds_write_b128 v30, a[92:95] offset:7168
    v_rcp_f32 v4, v4
    v_mfma_f32_16x16x32_bf16 a[112:115], v[220:223], v[96:99], a[112:115]
    v_rcp_f32 v5, v5
    v_mfma_f32_16x16x32_bf16 a[116:119], v[224:227], v[96:99], a[116:119]
    s_waitcnt lgkmcnt(15)
    v_pk_add_f32 v[132:133], v[132:133], v[36:37]
    v_pk_add_f32 v[134:135], v[134:135], v[38:39]
    v_pk_add_f32 v[132:133], v[132:133], v[44:45]
    v_pk_add_f32 v[134:135], v[134:135], v[46:47]
    s_waitcnt lgkmcnt(13)
    v_pk_add_f32 v[132:133], v[132:133], v[64:65]
    v_pk_add_f32 v[134:135], v[134:135], v[66:67]
    ds_write_b32 v31, a152 offset:24
    v_pk_add_f32 v[136:137], v[136:137], v[40:41]
    v_pk_add_f32 v[138:139], v[138:139], v[42:43]
    v_pk_add_f32 v[136:137], v[136:137], v[48:49]
    v_pk_add_f32 v[138:139], v[138:139], v[50:51]
    s_waitcnt lgkmcnt(13)
    v_pk_add_f32 v[136:137], v[136:137], v[68:69]
    ds_write_b128 v30, a[96:99] offset:32768
    v_pk_add_f32 v[138:139], v[138:139], v[70:71]
    v_pk_mul_f32 v[132:133], v[132:133], v[4:5] op_sel:[0,0] op_sel_hi:[1,0]
    v_pk_mul_f32 v[134:135], v[134:135], v[4:5] op_sel:[0,0] op_sel_hi:[1,0]
    v_pk_mul_f32 v[136:137], v[136:137], v[4:5] op_sel:[0,0] op_sel_hi:[1,0]
    v_pk_mul_f32 v[138:139], v[138:139], v[4:5] op_sel:[0,0] op_sel_hi:[1,0]
    ds_write_b128 v30, a[100:103] offset:33792
    v_cvt_pk_bf16_f32 v132, v132, v133
    v_cvt_pk_bf16_f32 v133, v134, v135
    v_cvt_pk_bf16_f32 v134, v136, v137
    v_cvt_pk_bf16_f32 v135, v138, v139
    s_mov_b32 s43, 0
    ds_write_b128 v30, a[104:107] offset:34816
    buffer_store_dwordx4 v[132:135], v28, s[20:23], s43 offen offset:0 sc1
    s_waitcnt lgkmcnt(14)
    v_pk_add_f32 v[140:141], v[140:141], v[100:101]
    v_pk_add_f32 v[142:143], v[142:143], v[102:103]
    s_waitcnt lgkmcnt(11)
    v_pk_add_f32 v[140:141], v[140:141], v[108:109]
    v_pk_add_f32 v[142:143], v[142:143], v[110:111]
    ds_write_b128 v30, a[108:111] offset:35840
    s_waitcnt lgkmcnt(9)
    v_pk_add_f32 v[140:141], v[140:141], v[116:117]
    v_pk_add_f32 v[142:143], v[142:143], v[118:119]
    v_pk_add_f32 v[144:145], v[144:145], v[104:105]
    v_pk_add_f32 v[146:147], v[146:147], v[106:107]
    v_pk_add_f32 v[144:145], v[144:145], v[112:113]
    ds_write_b128 v30, a[112:115] offset:36864
    v_pk_add_f32 v[146:147], v[146:147], v[114:115]
    s_waitcnt lgkmcnt(9)
    v_pk_add_f32 v[144:145], v[144:145], v[120:121]
    v_pk_add_f32 v[146:147], v[146:147], v[122:123]
    v_pk_mul_f32 v[140:141], v[140:141], v[4:5] op_sel:[0,1] op_sel_hi:[1,1]
    v_pk_mul_f32 v[142:143], v[142:143], v[4:5] op_sel:[0,1] op_sel_hi:[1,1]
    ds_write_b128 v30, a[116:119] offset:37888
    v_pk_mul_f32 v[144:145], v[144:145], v[4:5] op_sel:[0,1] op_sel_hi:[1,1]
    v_pk_mul_f32 v[146:147], v[146:147], v[4:5] op_sel:[0,1] op_sel_hi:[1,1]
    v_cvt_pk_bf16_f32 v140, v140, v141
    v_cvt_pk_bf16_f32 v141, v142, v143
    v_cvt_pk_bf16_f32 v142, v144, v145
    v_cvt_pk_bf16_f32 v143, v146, v147
    s_mov_b32 s43, 131072
    buffer_store_dwordx4 v[140:143], v28, s[20:23], s43 offen offset:0 sc1
    s_waitcnt lgkmcnt(0)
    s_barrier
    s_add_u32 s38, s52, 0
    s_add_u32 m0, s36, 0
    s_nop 0
    buffer_load_dwordx4 v235, s[24:27], s38 offen offset:0 lds
    ds_read_b128 v[76:79], v234 offset:16
    ds_read_b128 v[80:83], v234 offset:8208
    s_add_u32 s38, s52, 16384
    s_add_u32 m0, s36, 4096
    s_nop 0
    buffer_load_dwordx4 v235, s[24:27], s38 offen offset:0 lds
    ds_read_b128 v[84:87], v234 offset:16400
    ds_read_b128 v[88:91], v234 offset:24592
    ds_read_b128 v[164:167], v228 offset:36864
    ds_read_b128 v[168:171], v228 offset:37888
    ds_read_b128 v[172:175], v230 offset:38912
    ds_read_b128 v[176:179], v230 offset:39936
    ds_read_b128 v[180:183], v233 offset:0
    ds_read_b128 v[184:187], v233 offset:1024
    ds_read_b128 v[188:191], v229 offset:2048
    ds_read_b128 v[192:195], v229 offset:3072
    ds_read_b128 v[196:199], v231 offset:4096
    ds_read_b128 v[200:203], v231 offset:5120
    ds_read_b128 v[204:207], v233 offset:6144
    ds_read_b128 v[208:211], v233 offset:7168
    s_waitcnt lgkmcnt(14)
    v_add_f32 v6, v76, v80
    s_waitcnt lgkmcnt(12)
    v_add_f32 v84, v84, v88
    v_add_f32 v6, v6, v84
    v_add_f32 v7, v77, v81
    v_add_f32 v85, v85, v89
    v_add_f32 v7, v7, v85
    v_add_f32 v8, v78, v82
    v_add_f32 v86, v86, v90
    v_add_f32 v8, v8, v86
    v_min3_f32 v76, v6, v7, v8
    v_add_f32 v77, v6, v7
    v_add_f32 v77, v77, v8
    v_cmp_nle_f32 vcc, 0x2b800000, v76
    s_nop 1
    s_mov_b64 s[74:75], vcc
    v_cmp_nge_f32 vcc, 0x53800000, v77
    s_nop 1
    s_or_b64 vcc, vcc, s[74:75]
    s_and_b64 vcc, vcc, s[70:71]
    s_cbranch_vccnz L_redo
    v_rcp_f32 v6, v6
    v_rcp_f32 v7, v7
    v_rcp_f32 v8, v8
    ds_read_b128 v[100:103], v229 offset:32768
    ds_read_b128 v[104:107], v229 offset:33792
    ds_read_b128 v[108:111], v231 offset:34816
    ds_read_b128 v[112:115], v231 offset:35840
    ds_read_b128 v[116:119], v233 offset:36864
    ds_read_b128 v[120:123], v233 offset:37888
    s_waitcnt lgkmcnt(15)
    v_pk_add_f32 v[148:149], v[148:149], v[164:165]
    v_pk_add_f32 v[150:151], v[150:151], v[166:167]
    v_pk_add_f32 v[148:149], v[148:149], v[172:173]
    v_pk_add_f32 v[150:151], v[150:151], v[174:175]
    s_waitcnt lgkmcnt(13)
    v_pk_add_f32 v[148:149], v[148:149], v[180:181]
    v_pk_add_f32 v[150:151], v[150:151], v[182:183]
    v_pk_add_f32 v[152:153], v[152:153], v[168:169]
    v_pk_add_f32 v[154:155], v[154:155], v[170:171]
    v_pk_add_f32 v[152:153], v[152:153], v[176:177]
    v_pk_add_f32 v[154:155], v[154:155], v[178:179]
    s_waitcnt lgkmcnt(12)
    v_pk_add_f32 v[152:153], v[152:153], v[184:185]
    v_pk_add_f32 v[154:155], v[154:155], v[186:187]
    v_pk_mul_f32 v[148:149], v[148:149], v[6:7] op_sel:[0,0] op_sel_hi:[1,0]
    v_pk_mul_f32 v[150:151], v[150:151], v[6:7] op_sel:[0,0] op_sel_hi:[1,0]
    v_pk_mul_f32 v[152:153], v[152:153], v[6:7] op_sel:[0,0] op_sel_hi:[1,0]
    v_pk_mul_f32 v[154:155], v[154:155], v[6:7] op_sel:[0,0] op_sel_hi:[1,0]
    v_cvt_pk_bf16_f32 v148, v148, v149
    v_cvt_pk_bf16_f32 v149, v150, v151
    v_cvt_pk_bf16_f32 v150, v152, v153
    v_cvt_pk_bf16_f32 v151, v154, v155
    s_mov_b32 s43, 262144
    buffer_store_dwordx4 v[148:151], v28, s[20:23], s43 offen offset:0 sc1
    s_waitcnt lgkmcnt(11)
    v_pk_add_f32 v[156:157], v[156:157], v[188:189]
    v_pk_add_f32 v[158:159], v[158:159], v[190:191]
    s_waitcnt lgkmcnt(9)
    v_pk_add_f32 v[156:157], v[156:157], v[196:197]
    v_pk_add_f32 v[158:159], v[158:159], v[198:199]
    s_waitcnt lgkmcnt(7)
    v_pk_add_f32 v[156:157], v[156:157], v[204:205]
    v_pk_add_f32 v[158:159], v[158:159], v[206:207]
    v_pk_add_f32 v[160:161], v[160:161], v[192:193]
    v_pk_add_f32 v[162:163], v[162:163], v[194:195]
    v_pk_add_f32 v[160:161], v[160:161], v[200:201]
    v_pk_add_f32 v[162:163], v[162:163], v[202:203]
    s_waitcnt lgkmcnt(6)
    v_pk_add_f32 v[160:161], v[160:161], v[208:209]
    v_pk_add_f32 v[162:163], v[162:163], v[210:211]
    v_pk_mul_f32 v[156:157], v[156:157], v[6:7] op_sel:[0,1] op_sel_hi:[1,1]
    v_pk_mul_f32 v[158:159], v[158:159], v[6:7] op_sel:[0,1] op_sel_hi:[1,1]
    v_pk_mul_f32 v[160:161], v[160:161], v[6:7] op_sel:[0,1] op_sel_hi:[1,1]
    v_pk_mul_f32 v[162:163], v[162:163], v[6:7] op_sel:[0,1] op_sel_hi:[1,1]
    v_cvt_pk_bf16_f32 v156, v156, v157
    v_cvt_pk_bf16_f32 v157, v158, v159
    v_cvt_pk_bf16_f32 v158, v160, v161
    v_cvt_pk_bf16_f32 v159, v162, v163
    s_mov_b32 s43, 393216
    buffer_store_dwordx4 v[156:159], v28, s[20:23], s43 offen offset:0 sc1
    s_waitcnt lgkmcnt(5)
    v_pk_add_f32 v[56:57], v[56:57], v[100:101]
    v_pk_add_f32 v[58:59], v[58:59], v[102:103]
    s_waitcnt lgkmcnt(3)
    v_pk_add_f32 v[56:57], v[56:57], v[108:109]
    v_pk_add_f32 v[58:59], v[58:59], v[110:111]
    s_waitcnt lgkmcnt(1)
    v_pk_add_f32 v[56:57], v[56:57], v[116:117]
    v_pk_add_f32 v[58:59], v[58:59], v[118:119]
    v_pk_add_f32 v[60:61], v[60:61], v[104:105]
    v_pk_add_f32 v[62:63], v[62:63], v[106:107]
    v_pk_add_f32 v[60:61], v[60:61], v[112:113]
    v_pk_add_f32 v[62:63], v[62:63], v[114:115]
    s_waitcnt lgkmcnt(0)
    v_pk_add_f32 v[60:61], v[60:61], v[120:121]
    v_pk_add_f32 v[62:63], v[62:63], v[122:123]
    v_pk_mul_f32 v[56:57], v[56:57], v[8:9] op_sel:[0,0] op_sel_hi:[1,0]
    v_pk_mul_f32 v[58:59], v[58:59], v[8:9] op_sel:[0,0] op_sel_hi:[1,0]
    v_pk_mul_f32 v[60:61], v[60:61], v[8:9] op_sel:[0,0] op_sel_hi:[1,0]
    v_pk_mul_f32 v[62:63], v[62:63], v[8:9] op_sel:[0,0] op_sel_hi:[1,0]
    v_cvt_pk_bf16_f32 v56, v56, v57
    v_cvt_pk_bf16_f32 v57, v58, v59
    v_cvt_pk_bf16_f32 v58, v60, v61
    v_cvt_pk_bf16_f32 v59, v62, v63
    s_mov_b32 s43, 524288
    buffer_store_dwordx4 v[56:59], v28, s[20:23], s43 offen offset:0 sc1
    s_barrier
    ds_write_b128 v243, v[132:135] offset:0
    ds_write_b128 v243, v[140:143] offset:1024
    ds_write_b128 v243, v[148:151] offset:2048
    ds_write_b128 v243, v[156:159] offset:3072
    ds_write_b128 v243, v[56:59] offset:4096
    s_add_u32 s38, s52, 32768
    s_add_u32 m0, s36, 8192
    s_nop 0
    buffer_load_dwordx4 v235, s[24:27], s38 offen offset:0 lds
    ds_read_b64_tr_b16 a[160:161], v240 offset:0
    ds_read_b64_tr_b16 a[162:163], v240 offset:4096
    ds_read_b64_tr_b16 a[164:165], v241 offset:0
    s_add_u32 s38, s52, 49152
    s_add_u32 m0, s36, 12288
    s_nop 0
    buffer_load_dwordx4 v235, s[24:27], s38 offen offset:0 lds
    ds_read_b64_tr_b16 a[166:167], v241 offset:4096
    ds_read_b64_tr_b16 a[168:169], v240 offset:8192
    ds_read_b64_tr_b16 a[170:171], v240 offset:12288
    s_add_u32 s38, s52, 65536
    s_add_u32 m0, s36, 16384
    s_nop 0
    buffer_load_dwordx4 v235, s[24:27], s38 offen offset:0 lds
    ds_read_b64_tr_b16 a[172:173], v241 offset:8192
    ds_read_b64_tr_b16 a[174:175], v241 offset:12288
    ds_read_b64_tr_b16 a[176:177], v240 offset:16384
    s_add_u32 s38, s52, 81920
    s_add_u32 m0, s36, 20480
    s_nop 0
    buffer_load_dwordx4 v235, s[24:27], s38 offen offset:0 lds
    ds_read_b64_tr_b16 a[178:179], v240 offset:20480
    ds_read_b64_tr_b16 a[180:181], v241 offset:16384
    ds_read_b64_tr_b16 a[182:183], v241 offset:20480
    s_add_u32 s38, s52, 98304
    s_add_u32 m0, s36, 24576
    s_nop 0
    buffer_load_dwordx4 v235, s[24:27], s38 offen offset:0 lds
    ds_read_b64_tr_b16 a[184:185], v240 offset:24576
    ds_read_b64_tr_b16 a[186:187], v240 offset:28672
    ds_read_b64_tr_b16 a[188:189], v241 offset:24576
    s_add_u32 s38, s52, 114688
    s_add_u32 m0, s36, 28672
    s_nop 0
    buffer_load_dwordx4 v235, s[24:27], s38 offen offset:0 lds
    ds_read_b64_tr_b16 a[190:191], v241 offset:28672
    s_add_u32 s38, s53, 0
    s_add_u32 m0, s36, 32768
    s_nop 0
    buffer_load_dwordx4 v235, s[24:27], s38 offen offset:0 lds
    s_add_u32 s38, s53, 16384
    s_add_u32 m0, s36, 36864
    s_nop 0
    buffer_load_dwordx4 v235, s[24:27], s38 offen offset:0 lds
    s_add_u32 s38, s53, 32768
    s_add_u32 m0, s36, 40960
    s_nop 0
    buffer_load_dwordx4 v235, s[24:27], s38 offen offset:0 lds
    s_waitcnt lgkmcnt(0)
    s_barrier
    ds_read_b128 v[100:103], v242 offset:0
    ds_read_b128 v[104:107], v242 offset:1024
    ds_read_b128 v[108:111], v242 offset:2048
    ds_read_b128 v[112:115], v242 offset:3072
    ds_read_b128 v[116:119], v242 offset:4096
    ds_read_b128 v[64:67], v242 offset:5120
    ds_read_b128 v[68:71], v242 offset:6144
    ds_read_b128 v[72:75], v242 offset:7168
    ds_read_b128 v[76:79], v242 offset:8192
    ds_read_b128 v[80:83], v242 offset:9216
    s_waitcnt vmcnt(9)
    buffer_store_dwordx2 v[250:251], v248, s[56:59], 0 offen offset:0 sc1
    s_add_u32 s38, s53, 49152
    s_add_u32 m0, s36, 45056
    s_nop 0
    buffer_load_dwordx4 v235, s[24:27], s38 offen offset:0 lds
    s_add_u32 s38, s53, 65536
    s_add_u32 m0, s36, 49152
    s_nop 0
    buffer_load_dwordx4 v235, s[24:27], s38 offen offset:0 lds
    s_add_u32 s38, s53, 81920
    s_add_u32 m0, s36, 53248
    s_nop 0
    buffer_load_dwordx4 v235, s[24:27], s38 offen offset:0 lds
    s_add_u32 s38, s53, 98304
    s_add_u32 m0, s36, 57344
    s_nop 0
    buffer_load_dwordx4 v235, s[24:27], s38 offen offset:0 lds
    s_add_u32 s38, s53, 114688
    s_add_u32 m0, s36, 61440
    s_nop 0
    buffer_load_dwordx4 v235, s[24:27], s38 offen offset:0 lds
    s_add_u32 s38, s54, 0
    s_add_u32 m0, s36, 65536
    s_nop 0
    buffer_load_dwordx4 v235, s[24:27], s38 offen offset:0 lds
    s_add_u32 s38, s54, 16384
    s_add_u32 m0, s36, 69632
    s_nop 0
    buffer_load_dwordx4 v235, s[24:27], s38 offen offset:0 lds
    s_add_u32 s38, s54, 32768
    s_add_u32 m0, s36, 73728
    s_nop 0
    buffer_load_dwordx4 v235, s[24:27], s38 offen offset:0 lds
    s_add_u32 s38, s54, 49152
    s_add_u32 m0, s36, 77824
    s_nop 0
    buffer_load_dwordx4 v235, s[24:27], s38 offen offset:0 lds
    s_mov_b32 s73, 300000
L_poll1:
    s_load_dwordx8 s[4:11], s[56:57], s100 glc
    s_sub_u32 s73, s73, 1
    s_waitcnt lgkmcnt(0)
    s_cmp_eq_u32 s73, 0
    s_cbranch_scc1 L_poll1_done
    s_lshl_b32 s39, 1, s69
    s_cmp_eq_u64 s[4:5], s[96:97]
    s_cselect_b32 s40, 1, 0
    s_or_b32 s39, s39, s40
    s_cmp_eq_u64 s[6:7], s[96:97]
    s_cselect_b32 s40, 2, 0
    s_or_b32 s39, s39, s40
    s_cmp_eq_u64 s[8:9], s[96:97]
    s_cselect_b32 s40, 4, 0
    s_or_b32 s39, s39, s40
    s_cmp_eq_u64 s[10:11], s[96:97]
    s_cselect_b32 s40, 8, 0
    s_or_b32 s39, s39, s40
    s_cmp_lg_u32 s39, 15
    s_cbranch_scc1 L_poll1
L_poll1_done:
    s_lshr_b32 s42, s52, 5
    s_add_u32 s38, s42, 0
    s_add_u32 m0, s55, 143360
    s_nop 0
    buffer_load_dwordx4 v244, s[20:23], s38 offen offset:0 sc1 lds
    s_add_u32 s38, s42, 131072
    s_add_u32 m0, s55, 144384
    s_nop 0
    buffer_load_dwordx4 v244, s[20:23], s38 offen offset:0 sc1 lds
    s_add_u32 s38, s42, 262144
    s_add_u32 m0, s55, 145408
    s_nop 0
    buffer_load_dwordx4 v244, s[20:23], s38 offen offset:0 sc1 lds
    s_add_u32 s38, s42, 393216
    s_add_u32 m0, s55, 146432
    s_nop 0
    buffer_load_dwordx4 v244, s[20:23], s38 offen offset:0 sc1 lds
    s_add_u32 s38, s42, 524288
    s_add_u32 m0, s55, 147456
    s_nop 0
    buffer_load_dwordx4 v244, s[20:23], s38 offen offset:0 sc1 lds
    v_mfma_f32_16x16x32_bf16 v[164:167], a[160:163], v[100:103], 0
    s_lshr_b32 s42, s53, 5
    s_add_u32 s38, s42, 0
    s_add_u32 m0, s55, 122880
    ds_read_b128 v[204:207], v242 offset:10240
    v_mfma_f32_16x16x32_bf16 v[168:171], a[164:167], v[100:103], 0
    buffer_load_dwordx4 v244, s[20:23], s38 offen offset:0 sc1 lds
    ds_read_b128 v[208:211], v242 offset:11264
    v_mfma_f32_16x16x32_bf16 v[172:175], a[160:163], v[104:107], 0
    ds_read_b128 v[212:215], v242 offset:12288
    v_mfma_f32_16x16x32_bf16 v[176:179], a[164:167], v[104:107], 0
    s_add_u32 s38, s42, 131072
    ds_read_b128 v[216:219], v242 offset:13312
    v_mfma_f32_16x16x32_bf16 v[180:183], a[160:163], v[108:111], 0
    s_add_u32 m0, s55, 123904
    ds_read_b128 v[220:223], v242 offset:14336
    v_mfma_f32_16x16x32_bf16 v[184:187], a[164:167], v[108:111], 0
    buffer_load_dwordx4 v244, s[20:23], s38 offen offset:0 sc1 lds
    v_mfma_f32_16x16x32_bf16 v[188:191], a[160:163], v[112:115], 0
    v_mfma_f32_16x16x32_bf16 v[192:195], a[164:167], v[112:115], 0
    s_add_u32 s38, s42, 262144
    v_mfma_f32_16x16x32_bf16 v[196:199], a[160:163], v[116:119], 0
    s_add_u32 m0, s55, 124928
    v_mfma_f32_16x16x32_bf16 v[200:203], a[164:167], v[116:119], 0
    buffer_load_dwordx4 v244, s[20:23], s38 offen offset:0 sc1 lds
    v_mfma_f32_16x16x32_bf16 v[164:167], a[168:171], v[64:67], v[164:167]
    ds_read_b128 v[100:103], v242 offset:15360
    v_mfma_f32_16x16x32_bf16 v[168:171], a[172:175], v[64:67], v[168:171]
    s_add_u32 s38, s42, 393216
    ds_read_b128 v[104:107], v242 offset:16384
    v_mfma_f32_16x16x32_bf16 v[172:175], a[168:171], v[68:71], v[172:175]
    s_add_u32 m0, s55, 125952
    ds_read_b128 v[108:111], v242 offset:17408
    v_mfma_f32_16x16x32_bf16 v[176:179], a[172:175], v[68:71], v[176:179]
    buffer_load_dwordx4 v244, s[20:23], s38 offen offset:0 sc1 lds
    ds_read_b128 v[112:115], v242 offset:18432
    v_mfma_f32_16x16x32_bf16 v[180:183], a[168:171], v[72:75], v[180:183]
    ds_read_b128 v[116:119], v242 offset:19456
    v_mfma_f32_16x16x32_bf16 v[184:187], a[172:175], v[72:75], v[184:187]
    s_add_u32 s38, s42, 524288
    v_mfma_f32_16x16x32_bf16 v[188:191], a[168:171], v[76:79], v[188:191]
    s_add_u32 m0, s55, 126976
    v_mfma_f32_16x16x32_bf16 v[192:195], a[172:175], v[76:79], v[192:195]
    buffer_load_dwordx4 v244, s[20:23], s38 offen offset:0 sc1 lds
    v_mfma_f32_16x16x32_bf16 v[196:199], a[168:171], v[80:83], v[196:199]
    v_mfma_f32_16x16x32_bf16 v[200:203], a[172:175], v[80:83], v[200:203]
    s_waitcnt lgkmcnt(5)
    v_mfma_f32_16x16x32_bf16 v[164:167], a[176:179], v[204:207], v[164:167]
    s_add_u32 s38, s54, 65536
    s_add_u32 m0, s36, 81920
    v_mfma_f32_16x16x32_bf16 v[168:171], a[180:183], v[204:207], v[168:171]
    buffer_load_dwordx4 v235, s[24:27], s38 offen offset:0 lds
    v_mfma_f32_16x16x32_bf16 v[172:175], a[176:179], v[208:211], v[172:175]
    v_mfma_f32_16x16x32_bf16 v[176:179], a[180:183], v[208:211], v[176:179]
    s_add_u32 s38, s54, 81920
    v_mfma_f32_16x16x32_bf16 v[180:183], a[176:179], v[212:215], v[180:183]
    s_add_u32 m0, s36, 86016
    v_mfma_f32_16x16x32_bf16 v[184:187], a[180:183], v[212:215], v[184:187]
    buffer_load_dwordx4 v235, s[24:27], s38 offen offset:0 lds
    v_mfma_f32_16x16x32_bf16 v[188:191], a[176:179], v[216:219], v[188:191]
    v_mfma_f32_16x16x32_bf16 v[192:195], a[180:183], v[216:219], v[192:195]
    s_add_u32 s38, s54, 98304
    v_mfma_f32_16x16x32_bf16 v[196:199], a[176:179], v[220:223], v[196:199]
    s_add_u32 m0, s36, 90112
    v_mfma_f32_16x16x32_bf16 v[200:203], a[180:183], v[220:223], v[200:203]
    s_waitcnt lgkmcnt(0)
    buffer_load_dwordx4 v235, s[24:27], s38 offen offset:0 lds
    v_mfma_f32_16x16x32_bf16 v[164:167], a[184:187], v[100:103], v[164:167]
    v_mfma_f32_16x16x32_bf16 v[168:171], a[188:191], v[100:103], v[168:171]
    s_add_u32 s38, s54, 114688
    v_mfma_f32_16x16x32_bf16 v[172:175], a[184:187], v[104:107], v[172:175]
    s_add_u32 m0, s36, 94208
    v_mfma_f32_16x16x32_bf16 v[176:179], a[188:191], v[104:107], v[176:179]
    buffer_load_dwordx4 v235, s[24:27], s38 offen offset:0 lds
    v_mfma_f32_16x16x32_bf16 v[180:183], a[184:187], v[108:111], v[180:183]
    v_mfma_f32_16x16x32_bf16 v[184:187], a[188:191], v[108:111], v[184:187]
    v_mfma_f32_16x16x32_bf16 v[188:191], a[184:187], v[112:115], v[188:191]
    v_mfma_f32_16x16x32_bf16 v[192:195], a[188:191], v[112:115], v[192:195]
    v_mfma_f32_16x16x32_bf16 v[196:199], a[184:187], v[116:119], v[196:199]
    v_mfma_f32_16x16x32_bf16 v[200:203], a[188:191], v[116:119], v[200:203]
    s_waitcnt vmcnt(9)
    s_barrier
    ds_read_b64_tr_b16 v[84:85], v236 offset:0
    ds_read_b64_tr_b16 v[86:87], v236 offset:4096
    ds_read_b128 v[64:67], v242 offset:45056
    ds_read_b64_tr_b16 v[88:89], v237 offset:0
    ds_read_b64_tr_b16 v[90:91], v237 offset:4096
    ds_read_b128 v[68:71], v242 offset:46080
    ds_read_b128 v[72:75], v242 offset:47104
    ds_read_b128 v[76:79], v242 offset:48128
    ds_read_b128 v[80:83], v242 offset:49152
    ds_read_b64_tr_b16 v[36:37], v236 offset:8192
    ds_read_b64_tr_b16 v[38:39], v236 offset:12288
    ds_read_b128 v[204:207], v242 offset:50176
    ds_read_b64_tr_b16 v[40:41], v237 offset:8192
    ds_read_b64_tr_b16 v[42:43], v237 offset:12288
    ds_read_b128 v[208:211], v242 offset:51200
    ds_read_b128 v[212:215], v242 offset:52224
    ds_read_b128 v[216:219], v242 offset:53248
    ds_read_b128 v[220:223], v242 offset:54272
    s_waitcnt lgkmcnt(9)
    v_mfma_f32_16x16x32_bf16 v[164:167], v[84:87], v[64:67], v[164:167]
    s_lshr_b32 s42, s54, 5
    s_add_u32 s38, s42, 0
    s_add_u32 m0, s55, 102400
    ds_read_b64_tr_b16 v[120:121], v236 offset:16384
    v_mfma_f32_16x16x32_bf16 v[168:171], v[88:91], v[64:67], v[168:171]
    buffer_load_dwordx4 v244, s[20:23], s38 offen offset:0 sc1 lds
    ds_read_b64_tr_b16 v[122:123], v236 offset:20480
    v_mfma_f32_16x16x32_bf16 v[172:175], v[84:87], v[68:71], v[172:175]
    ds_read_b128 v[100:103], v242 offset:55296
    v_mfma_f32_16x16x32_bf16 v[176:179], v[88:91], v[68:71], v[176:179]
    s_add_u32 s38, s42, 131072
    ds_read_b64_tr_b16 v[124:125], v237 offset:16384
    v_mfma_f32_16x16x32_bf16 v[180:183], v[84:87], v[72:75], v[180:183]
    s_add_u32 m0, s55, 103424
    ds_read_b64_tr_b16 v[126:127], v237 offset:20480
    v_mfma_f32_16x16x32_bf16 v[184:187], v[88:91], v[72:75], v[184:187]
    buffer_load_dwordx4 v244, s[20:23], s38 offen offset:0 sc1 lds
    ds_read_b128 v[104:107], v242 offset:56320
    v_mfma_f32_16x16x32_bf16 v[188:191], v[84:87], v[76:79], v[188:191]
    ds_read_b128 v[108:111], v242 offset:57344
    v_mfma_f32_16x16x32_bf16 v[192:195], v[88:91], v[76:79], v[192:195]
    s_add_u32 s38, s42, 262144
    ds_read_b128 v[112:115], v242 offset:58368
    v_mfma_f32_16x16x32_bf16 v[196:199], v[84:87], v[80:83], v[196:199]
    s_add_u32 m0, s55, 104448
    ds_read_b128 v[116:119], v242 offset:59392
    v_mfma_f32_16x16x32_bf16 v[200:203], v[88:91], v[80:83], v[200:203]
    s_waitcnt lgkmcnt(9)
    buffer_load_dwordx4 v244, s[20:23], s38 offen offset:0 sc1 lds
    v_mfma_f32_16x16x32_bf16 v[164:167], v[36:39], v[204:207], v[164:167]
    ds_read_b64_tr_b16 v[84:85], v236 offset:24576
    v_mfma_f32_16x16x32_bf16 v[168:171], v[40:43], v[204:207], v[168:171]
    s_add_u32 s38, s42, 393216
    ds_read_b64_tr_b16 v[86:87], v236 offset:28672
    v_mfma_f32_16x16x32_bf16 v[172:175], v[36:39], v[208:211], v[172:175]
    s_add_u32 m0, s55, 105472
    ds_read_b128 v[64:67], v242 offset:60416
    v_mfma_f32_16x16x32_bf16 v[176:179], v[40:43], v[208:211], v[176:179]
    buffer_load_dwordx4 v244, s[20:23], s38 offen offset:0 sc1 lds
    ds_read_b64_tr_b16 v[88:89], v237 offset:24576
    v_mfma_f32_16x16x32_bf16 v[180:183], v[36:39], v[212:215], v[180:183]
    ds_read_b64_tr_b16 v[90:91], v237 offset:28672
    v_mfma_f32_16x16x32_bf16 v[184:187], v[40:43], v[212:215], v[184:187]
    s_add_u32 s38, s42, 524288
    ds_read_b128 v[68:71], v242 offset:61440
    v_mfma_f32_16x16x32_bf16 v[188:191], v[36:39], v[216:219], v[188:191]
    s_add_u32 m0, s55, 106496
    ds_read_b128 v[72:75], v242 offset:62464
    v_mfma_f32_16x16x32_bf16 v[192:195], v[40:43], v[216:219], v[192:195]
    buffer_load_dwordx4 v244, s[20:23], s38 offen offset:0 sc1 lds
    ds_read_b128 v[76:79], v242 offset:63488
    v_mfma_f32_16x16x32_bf16 v[196:199], v[36:39], v[220:223], v[196:199]
    ds_read_b128 v[80:83], v242 offset:64512
    v_mfma_f32_16x16x32_bf16 v[200:203], v[40:43], v[220:223], v[200:203]
    s_waitcnt vmcnt(9)
    s_barrier
    s_waitcnt lgkmcnt(9)
    v_mfma_f32_16x16x32_bf16 v[164:167], v[120:123], v[100:103], v[164:167]
    ds_read_b64_tr_b16 v[36:37], v236 offset:32768
    v_mfma_f32_16x16x32_bf16 v[168:171], v[124:127], v[100:103], v[168:171]
    ds_read_b64_tr_b16 v[38:39], v236 offset:36864
    v_mfma_f32_16x16x32_bf16 v[172:175], v[120:123], v[104:107], v[172:175]
    ds_read_b128 v[204:207], v242 offset:24576
    v_mfma_f32_16x16x32_bf16 v[176:179], v[124:127], v[104:107], v[176:179]
    ds_read_b64_tr_b16 v[40:41], v237 offset:32768
    v_mfma_f32_16x16x32_bf16 v[180:183], v[120:123], v[108:111], v[180:183]
    ds_read_b64_tr_b16 v[42:43], v237 offset:36864
    v_mfma_f32_16x16x32_bf16 v[184:187], v[124:127], v[108:111], v[184:187]
    ds_read_b128 v[208:211], v242 offset:25600
    v_mfma_f32_16x16x32_bf16 v[188:191], v[120:123], v[112:115], v[188:191]
    ds_read_b128 v[212:215], v242 offset:26624
    v_mfma_f32_16x16x32_bf16 v[192:195], v[124:127], v[112:115], v[192:195]
    ds_read_b128 v[216:219], v242 offset:27648
    v_mfma_f32_16x16x32_bf16 v[196:199], v[120:123], v[116:119], v[196:199]
    ds_read_b128 v[220:223], v242 offset:28672
    v_mfma_f32_16x16x32_bf16 v[200:203], v[124:127], v[116:119], v[200:203]
    s_waitcnt lgkmcnt(9)
    v_mfma_f32_16x16x32_bf16 v[164:167], v[84:87], v[64:67], v[164:167]
    ds_read_b64_tr_b16 v[120:121], v236 offset:40960
    v_mfma_f32_16x16x32_bf16 v[168:171], v[88:91], v[64:67], v[168:171]
    ds_read_b64_tr_b16 v[122:123], v236 offset:45056
    v_mfma_f32_16x16x32_bf16 v[172:175], v[84:87], v[68:71], v[172:175]
    ds_read_b128 v[100:103], v242 offset:29696
    v_mfma_f32_16x16x32_bf16 v[176:179], v[88:91], v[68:71], v[176:179]
    ds_read_b64_tr_b16 v[124:125], v237 offset:40960
    v_mfma_f32_16x16x32_bf16 v[180:183], v[84:87], v[72:75], v[180:183]
    ds_read_b64_tr_b16 v[126:127], v237 offset:45056
    v_mfma_f32_16x16x32_bf16 v[184:187], v[88:91], v[72:75], v[184:187]
    ds_read_b128 v[104:107], v242 offset:30720
    v_mfma_f32_16x16x32_bf16 v[188:191], v[84:87], v[76:79], v[188:191]
    ds_read_b128 v[108:111], v242 offset:31744
    v_mfma_f32_16x16x32_bf16 v[192:195], v[88:91], v[76:79], v[192:195]
    ds_read_b128 v[112:115], v242 offset:32768
    v_mfma_f32_16x16x32_bf16 v[196:199], v[84:87], v[80:83], v[196:199]
    ds_read_b128 v[116:119], v242 offset:33792
    v_mfma_f32_16x16x32_bf16 v[200:203], v[88:91], v[80:83], v[200:203]
    s_waitcnt lgkmcnt(9)
    v_mfma_f32_16x16x32_bf16 v[164:167], v[36:39], v[204:207], v[164:167]
    ds_read_b64_tr_b16 v[84:85], v236 offset:49152
    v_mfma_f32_16x16x32_bf16 v[168:171], v[40:43], v[204:207], v[168:171]
    ds_read_b64_tr_b16 v[86:87], v236 offset:53248
    v_mfma_f32_16x16x32_bf16 v[172:175], v[36:39], v[208:211], v[172:175]
    ds_read_b128 v[64:67], v242 offset:34816
    v_mfma_f32_16x16x32_bf16 v[176:179], v[40:43], v[208:211], v[176:179]
    ds_read_b64_tr_b16 v[88:89], v237 offset:49152
    v_mfma_f32_16x16x32_bf16 v[180:183], v[36:39], v[212:215], v[180:183]
    ds_read_b64_tr_b16 v[90:91], v237 offset:53248
    v_mfma_f32_16x16x32_bf16 v[184:187], v[40:43], v[212:215], v[184:187]
    ds_read_b128 v[68:71], v242 offset:35840
    v_mfma_f32_16x16x32_bf16 v[188:191], v[36:39], v[216:219], v[188:191]
    ds_read_b128 v[72:75], v242 offset:36864
    v_mfma_f32_16x16x32_bf16 v[192:195], v[40:43], v[216:219], v[192:195]
    ds_read_b128 v[76:79], v242 offset:37888
    v_mfma_f32_16x16x32_bf16 v[196:199], v[36:39], v[220:223], v[196:199]
    ds_read_b128 v[80:83], v242 offset:38912
    v_mfma_f32_16x16x32_bf16 v[200:203], v[40:43], v[220:223], v[200:203]
    s_waitcnt lgkmcnt(9)
    v_mfma_f32_16x16x32_bf16 v[164:167], v[120:123], v[100:103], v[164:167]
    ds_read_b64_tr_b16 v[36:37], v236 offset:57344
    v_mfma_f32_16x16x32_bf16 v[168:171], v[124:127], v[100:103], v[168:171]
    ds_read_b64_tr_b16 v[38:39], v236 offset:61440
    v_mfma_f32_16x16x32_bf16 v[172:175], v[120:123], v[104:107], v[172:175]
    ds_read_b128 v[204:207], v242 offset:39936
    v_mfma_f32_16x16x32_bf16 v[176:179], v[124:127], v[104:107], v[176:179]
    ds_read_b64_tr_b16 v[40:41], v237 offset:57344
    v_mfma_f32_16x16x32_bf16 v[180:183], v[120:123], v[108:111], v[180:183]
    ds_read_b64_tr_b16 v[42:43], v237 offset:61440
    v_mfma_f32_16x16x32_bf16 v[184:187], v[124:127], v[108:111], v[184:187]
    ds_read_b128 v[208:211], v242 offset:40960
    v_mfma_f32_16x16x32_bf16 v[188:191], v[120:123], v[112:115], v[188:191]
    ds_read_b128 v[212:215], v242 offset:41984
    v_mfma_f32_16x16x32_bf16 v[192:195], v[124:127], v[112:115], v[192:195]
    ds_read_b128 v[216:219], v242 offset:43008
    v_mfma_f32_16x16x32_bf16 v[196:199], v[120:123], v[116:119], v[196:199]
    ds_read_b128 v[220:223], v242 offset:44032
    v_mfma_f32_16x16x32_bf16 v[200:203], v[124:127], v[116:119], v[200:203]
    s_waitcnt vmcnt(0)
    s_barrier
    s_waitcnt lgkmcnt(9)
    v_mfma_f32_16x16x32_bf16 v[164:167], v[84:87], v[64:67], v[164:167]
    ds_read_b64_tr_b16 v[120:121], v238 offset:0
    v_mfma_f32_16x16x32_bf16 v[168:171], v[88:91], v[64:67], v[168:171]
    ds_read_b64_tr_b16 v[122:123], v238 offset:4096
    v_mfma_f32_16x16x32_bf16 v[172:175], v[84:87], v[68:71], v[172:175]
    ds_read_b128 v[100:103], v242 offset:4096
    v_mfma_f32_16x16x32_bf16 v[176:179], v[88:91], v[68:71], v[176:179]
    ds_read_b64_tr_b16 v[124:125], v239 offset:0
    v_mfma_f32_16x16x32_bf16 v[180:183], v[84:87], v[72:75], v[180:183]
    ds_read_b64_tr_b16 v[126:127], v239 offset:4096
    v_mfma_f32_16x16x32_bf16 v[184:187], v[88:91], v[72:75], v[184:187]
    ds_read_b128 v[104:107], v242 offset:5120
    v_mfma_f32_16x16x32_bf16 v[188:191], v[84:87], v[76:79], v[188:191]
    ds_read_b128 v[108:111], v242 offset:6144
    v_mfma_f32_16x16x32_bf16 v[192:195], v[88:91], v[76:79], v[192:195]
    ds_read_b128 v[112:115], v242 offset:7168
    v_mfma_f32_16x16x32_bf16 v[196:199], v[84:87], v[80:83], v[196:199]
    ds_read_b128 v[116:119], v242 offset:8192
    v_mfma_f32_16x16x32_bf16 v[200:203], v[88:91], v[80:83], v[200:203]
    s_waitcnt lgkmcnt(9)
    v_mfma_f32_16x16x32_bf16 v[164:167], v[36:39], v[204:207], v[164:167]
    ds_read_b64_tr_b16 v[84:85], v238 offset:8192
    v_mfma_f32_16x16x32_bf16 v[168:171], v[40:43], v[204:207], v[168:171]
    ds_read_b64_tr_b16 v[86:87], v238 offset:12288
    v_mfma_f32_16x16x32_bf16 v[172:175], v[36:39], v[208:211], v[172:175]
    ds_read_b128 v[64:67], v242 offset:9216
    v_mfma_f32_16x16x32_bf16 v[176:179], v[40:43], v[208:211], v[176:179]
    ds_read_b64_tr_b16 v[88:89], v239 offset:8192
    v_mfma_f32_16x16x32_bf16 v[180:183], v[36:39], v[212:215], v[180:183]
    ds_read_b64_tr_b16 v[90:91], v239 offset:12288
    v_mfma_f32_16x16x32_bf16 v[184:187], v[40:43], v[212:215], v[184:187]
    ds_read_b128 v[68:71], v242 offset:10240
    v_mfma_f32_16x16x32_bf16 v[188:191], v[36:39], v[216:219], v[188:191]
    ds_read_b128 v[72:75], v242 offset:11264
    v_mfma_f32_16x16x32_bf16 v[192:195], v[40:43], v[216:219], v[192:195]
    ds_read_b128 v[76:79], v242 offset:12288
    v_mfma_f32_16x16x32_bf16 v[196:199], v[36:39], v[220:223], v[196:199]
    ds_read_b128 v[80:83], v242 offset:13312
    v_mfma_f32_16x16x32_bf16 v[200:203], v[40:43], v[220:223], v[200:203]
    s_waitcnt lgkmcnt(9)
    v_mfma_f32_16x16x32_bf16 v[164:167], v[120:123], v[100:103], v[164:167]
    ds_read_b64_tr_b16 v[36:37], v238 offset:16384
    v_mfma_f32_16x16x32_bf16 v[168:171], v[124:127], v[100:103], v[168:171]
    ds_read_b64_tr_b16 v[38:39], v238 offset:20480
    v_mfma_f32_16x16x32_bf16 v[172:175], v[120:123], v[104:107], v[172:175]
    ds_read_b128 v[204:207], v242 offset:14336
    v_mfma_f32_16x16x32_bf16 v[176:179], v[124:127], v[104:107], v[176:179]
    ds_read_b64_tr_b16 v[40:41], v239 offset:16384
    v_mfma_f32_16x16x32_bf16 v[180:183], v[120:123], v[108:111], v[180:183]
    ds_read_b64_tr_b16 v[42:43], v239 offset:20480
    v_mfma_f32_16x16x32_bf16 v[184:187], v[124:127], v[108:111], v[184:187]
    ds_read_b128 v[208:211], v242 offset:15360
    v_mfma_f32_16x16x32_bf16 v[188:191], v[120:123], v[112:115], v[188:191]
    ds_read_b128 v[212:215], v242 offset:16384
    v_mfma_f32_16x16x32_bf16 v[192:195], v[124:127], v[112:115], v[192:195]
    ds_read_b128 v[216:219], v242 offset:17408
    v_mfma_f32_16x16x32_bf16 v[196:199], v[120:123], v[116:119], v[196:199]
    ds_read_b128 v[220:223], v242 offset:18432
    v_mfma_f32_16x16x32_bf16 v[200:203], v[124:127], v[116:119], v[200:203]
    s_waitcnt lgkmcnt(9)
    v_mfma_f32_16x16x32_bf16 v[164:167], v[84:87], v[64:67], v[164:167]
    ds_read_b64_tr_b16 v[120:121], v238 offset:24576
    v_mfma_f32_16x16x32_bf16 v[168:171], v[88:91], v[64:67], v[168:171]
    ds_read_b64_tr_b16 v[122:123], v238 offset:28672
    v_mfma_f32_16x16x32_bf16 v[172:175], v[84:87], v[68:71], v[172:175]
    ds_read_b128 v[100:103], v242 offset:19456
    v_mfma_f32_16x16x32_bf16 v[176:179], v[88:91], v[68:71], v[176:179]
    ds_read_b64_tr_b16 v[124:125], v239 offset:24576
    v_mfma_f32_16x16x32_bf16 v[180:183], v[84:87], v[72:75], v[180:183]
    ds_read_b64_tr_b16 v[126:127], v239 offset:28672
    v_mfma_f32_16x16x32_bf16 v[184:187], v[88:91], v[72:75], v[184:187]
    ds_read_b128 v[104:107], v242 offset:20480
    v_mfma_f32_16x16x32_bf16 v[188:191], v[84:87], v[76:79], v[188:191]
    ds_read_b128 v[108:111], v242 offset:21504
    v_mfma_f32_16x16x32_bf16 v[192:195], v[88:91], v[76:79], v[192:195]
    ds_read_b128 v[112:115], v242 offset:22528
    v_mfma_f32_16x16x32_bf16 v[196:199], v[84:87], v[80:83], v[196:199]
    ds_read_b128 v[116:119], v242 offset:23552
    v_mfma_f32_16x16x32_bf16 v[200:203], v[88:91], v[80:83], v[200:203]
    s_waitcnt lgkmcnt(9)
    v_mfma_f32_16x16x32_bf16 v[164:167], v[36:39], v[204:207], v[164:167]
    s_waitcnt lgkmcnt(4)
    v_mfma_f32_16x16x32_bf16 v[164:167], v[120:123], v[100:103], v[164:167]
    v_mfma_f32_16x16x32_bf16 v[168:171], v[40:43], v[204:207], v[168:171]
    v_mfma_f32_16x16x32_bf16 v[168:171], v[124:127], v[100:103], v[168:171]
    v_mfma_f32_16x16x32_bf16 v[172:175], v[36:39], v[208:211], v[172:175]
    s_waitcnt lgkmcnt(3)
    v_mfma_f32_16x16x32_bf16 v[172:175], v[120:123], v[104:107], v[172:175]
    v_mfma_f32_16x16x32_bf16 v[176:179], v[40:43], v[208:211], v[176:179]
    s_nop 1
    v_cvt_pk_bf16_f32 v164, v164, v165
    v_cvt_pk_bf16_f32 v165, v166, v167
    v_mfma_f32_16x16x32_bf16 v[176:179], v[124:127], v[104:107], v[176:179]
    v_cvt_pk_bf16_f32 v166, v168, v169
    v_cvt_pk_bf16_f32 v167, v170, v171
    v_mfma_f32_16x16x32_bf16 v[180:183], v[36:39], v[212:215], v[180:183]
    s_waitcnt lgkmcnt(2)
    buffer_store_dwordx4 v[164:167], v245, s[28:31], s44 offen offset:0 sc1
    v_mfma_f32_16x16x32_bf16 v[180:183], v[120:123], v[108:111], v[180:183]
    v_mfma_f32_16x16x32_bf16 v[184:187], v[40:43], v[212:215], v[184:187]
    v_cvt_pk_bf16_f32 v172, v172, v173
    v_cvt_pk_bf16_f32 v173, v174, v175
    v_mfma_f32_16x16x32_bf16 v[184:187], v[124:127], v[108:111], v[184:187]
    v_cvt_pk_bf16_f32 v174, v176, v177
    v_cvt_pk_bf16_f32 v175, v178, v179
    v_mfma_f32_16x16x32_bf16 v[188:191], v[36:39], v[216:219], v[188:191]
    s_waitcnt lgkmcnt(1)
    buffer_store_dwordx4 v[172:175], v245, s[28:31], s45 offen offset:0 sc1
    v_mfma_f32_16x16x32_bf16 v[188:191], v[120:123], v[112:115], v[188:191]
    v_mfma_f32_16x16x32_bf16 v[192:195], v[40:43], v[216:219], v[192:195]
    v_cvt_pk_bf16_f32 v180, v180, v181
    v_cvt_pk_bf16_f32 v181, v182, v183
    v_mfma_f32_16x16x32_bf16 v[192:195], v[124:127], v[112:115], v[192:195]
    v_cvt_pk_bf16_f32 v182, v184, v185
    v_cvt_pk_bf16_f32 v183, v186, v187
    v_mfma_f32_16x16x32_bf16 v[196:199], v[36:39], v[220:223], v[196:199]
    s_waitcnt lgkmcnt(0)
    buffer_store_dwordx4 v[180:183], v245, s[28:31], s46 offen offset:0 sc1
    v_mfma_f32_16x16x32_bf16 v[196:199], v[120:123], v[116:119], v[196:199]
    v_mfma_f32_16x16x32_bf16 v[200:203], v[40:43], v[220:223], v[200:203]
    v_mfma_f32_16x16x32_bf16 v[200:203], v[124:127], v[116:119], v[200:203]
    v_cvt_pk_bf16_f32 v188, v188, v189
    v_cvt_pk_bf16_f32 v189, v190, v191
    v_cvt_pk_bf16_f32 v190, v192, v193
    v_cvt_pk_bf16_f32 v191, v194, v195
    buffer_store_dwordx4 v[188:191], v245, s[28:31], s47 offen offset:0 sc1
    s_nop 0
    v_cvt_pk_bf16_f32 v196, v196, v197
    v_cvt_pk_bf16_f32 v197, v198, v199
    v_cvt_pk_bf16_f32 v198, v200, v201
    v_cvt_pk_bf16_f32 v199, v202, v203
    buffer_store_dwordx4 v[196:199], v245, s[28:31], s48 offen offset:0 sc1
    s_mov_b32 s38, 4096
    s_mov_b32 s40, 0xffff0000
    s_mov_b32 s73, 300000
    s_mov_b32 s41, 0
    s_mov_b32 s42, 0
    s_waitcnt vmcnt(0)
    s_barrier
    s_cmp_lg_u32 s32, 0
    s_cbranch_scc1 L_sig2
    buffer_store_dwordx2 v[250:251], v249, s[56:59], 0 offen offset:0 sc1
L_sig2:
    v_lshlrev_b32 v11, 4, v0
    v_and_b32 v10, 0xe0, v0
    v_lshlrev_b32 v10, 4, v10
    v_and_b32 v12, 7, v0
    v_lshl_add_u32 v10, v12, 6, v10
    v_bfe_u32 v12, v0, 3, 2
    v_lshl_add_u32 v10, v12, 3, v10
    s_cmp_eq_u32 s32, 3
    s_cbranch_scc1 L_fin
L_poll2:
    s_load_dwordx16 s[4:19], s[56:57], s101 glc
    s_sub_u32 s73, s73, 1
    s_waitcnt lgkmcnt(0)
    s_cmp_eq_u32 s73, 0
    s_cbranch_scc1 L_poll2_done
    s_cmp_lg_u64 s[4:5], s[96:97]
    s_cbranch_scc1 L_g0
    s_bitcmp1_b32 s41, 0
    s_cbranch_scc1 L_g0
    s_bitset1_b32 s41, 0
    s_bitset1_b32 s42, 0
    buffer_load_dwordx4 v[100:103], v246, s[28:31], 0 offen offset:0 sc1
L_g0:
    s_cmp_lg_u64 s[6:7], s[96:97]
    s_cbranch_scc1 L_g1
    s_bitcmp1_b32 s41, 1
    s_cbranch_scc1 L_g1
    s_bitset1_b32 s41, 1
    s_bitset1_b32 s42, 1
    buffer_load_dwordx4 v[104:107], v246, s[28:31], 0 offen offset:1024 sc1
L_g1:
    s_cmp_lg_u64 s[8:9], s[96:97]
    s_cbranch_scc1 L_g2
    s_bitcmp1_b32 s41, 2
    s_cbranch_scc1 L_g2
    s_bitset1_b32 s41, 2
    s_bitset1_b32 s42, 2
    buffer_load_dwordx4 v[108:111], v246, s[28:31], 0 offen offset:2048 sc1
L_g2:
    s_cmp_lg_u64 s[10:11], s[96:97]
    s_cbranch_scc1 L_g3
    s_bitcmp1_b32 s41, 3
    s_cbranch_scc1 L_g3
    s_bitset1_b32 s41, 3
    s_bitset1_b32 s42, 3
    buffer_load_dwordx4 v[112:115], v246, s[28:31], 0 offen offset:3072 sc1
L_g3:
    s_cmp_lg_u64 s[12:13], s[96:97]
    s_cbranch_scc1 L_g4
    s_bitcmp1_b32 s41, 4
    s_cbranch_scc1 L_g4
    s_bitset1_b32 s41, 4
    s_bitset1_b32 s42, 4
    buffer_load_dwordx4 v[116:119], v246, s[28:31], s38 offen offset:0 sc1
L_g4:
    s_cmp_lg_u64 s[14:15], s[96:97]
    s_cbranch_scc1 L_g5
    s_bitcmp1_b32 s41, 5
    s_cbranch_scc1 L_g5
    s_bitset1_b32 s41, 5
    s_bitset1_b32 s42, 5
    buffer_load_dwordx4 v[120:123], v246, s[28:31], s38 offen offset:1024 sc1
L_g5:
    s_cmp_lg_u64 s[16:17], s[96:97]
    s_cbranch_scc1 L_g6
    s_bitcmp1_b32 s41, 6
    s_cbranch_scc1 L_g6
    s_bitset1_b32 s41, 6
    s_bitset1_b32 s42, 6
    buffer_load_dwordx4 v[124:127], v246, s[28:31], s38 offen offset:2048 sc1
L_g6:
    s_cmp_lg_u64 s[18:19], s[96:97]
    s_cbranch_scc1 L_g7
    s_bitcmp1_b32 s41, 7
    s_cbranch_scc1 L_g7
    s_bitset1_b32 s41, 7
    s_bitset1_b32 s42, 7
    buffer_load_dwordx4 v[128:131], v246, s[28:31], s38 offen offset:3072 sc1
L_g7:
    s_cmp_eq_u32 s41, 0xff
    s_cbranch_scc1 L_poll2_done
    s_mov_b32 s42, 0
    s_branch L_poll2
L_poll2_done:
    s_waitcnt vmcnt(0)
    v_lshlrev_b32 v132, 16, v100
    v_and_b32 v133, s40, v100
    v_lshlrev_b32 v134, 16, v101
    v_and_b32 v135, s40, v101
    v_lshlrev_b32 v136, 16, v102
    v_and_b32 v137, s40, v102
    v_lshlrev_b32 v138, 16, v103
    v_and_b32 v139, s40, v103
    v_lshlrev_b32 v140, 16, v104
    v_and_b32 v141, s40, v104
    v_lshlrev_b32 v142, 16, v105
    v_and_b32 v143, s40, v105
    v_lshlrev_b32 v144, 16, v106
    v_and_b32 v145, s40, v106
    v_lshlrev_b32 v146, 16, v107
    v_and_b32 v147, s40, v107
    v_lshlrev_b32 v148, 16, v108
    v_and_b32 v149, s40, v108
    v_lshlrev_b32 v150, 16, v109
    v_and_b32 v151, s40, v109
    v_lshlrev_b32 v152, 16, v110
    v_and_b32 v153, s40, v110
    v_lshlrev_b32 v154, 16, v111
    v_and_b32 v155, s40, v111
    v_lshlrev_b32 v156, 16, v112
    v_and_b32 v157, s40, v112
    v_lshlrev_b32 v158, 16, v113
    v_and_b32 v159, s40, v113
    v_lshlrev_b32 v160, 16, v114
    v_and_b32 v161, s40, v114
    v_lshlrev_b32 v162, 16, v115
    v_and_b32 v163, s40, v115
    v_lshlrev_b32 v164, 16, v116
    v_and_b32 v165, s40, v116
    v_lshlrev_b32 v166, 16, v117
    v_and_b32 v167, s40, v117
    v_lshlrev_b32 v168, 16, v118
    v_and_b32 v169, s40, v118
    v_lshlrev_b32 v170, 16, v119
    v_and_b32 v171, s40, v119
    v_lshlrev_b32 v172, 16, v120
    v_and_b32 v173, s40, v120
    v_lshlrev_b32 v174, 16, v121
    v_and_b32 v175, s40, v121
    v_lshlrev_b32 v176, 16, v122
    v_and_b32 v177, s40, v122
    v_lshlrev_b32 v178, 16, v123
    v_and_b32 v179, s40, v123
    v_lshlrev_b32 v180, 16, v124
    v_and_b32 v181, s40, v124
    v_lshlrev_b32 v182, 16, v125
    v_and_b32 v183, s40, v125
    v_lshlrev_b32 v184, 16, v126
    v_and_b32 v185, s40, v126
    v_lshlrev_b32 v186, 16, v127
    v_and_b32 v187, s40, v127
    v_lshlrev_b32 v188, 16, v128
    v_and_b32 v189, s40, v128
    v_lshlrev_b32 v190, 16, v129
    v_and_b32 v191, s40, v129
    v_lshlrev_b32 v192, 16, v130
    v_and_b32 v193, s40, v130
    v_lshlrev_b32 v194, 16, v131
    v_and_b32 v195, s40, v131
    v_pk_add_f32 v[132:133], v[132:133], v[140:141]
    v_pk_add_f32 v[134:135], v[134:135], v[142:143]
    v_pk_add_f32 v[136:137], v[136:137], v[144:145]
    v_pk_add_f32 v[138:139], v[138:139], v[146:147]
    v_pk_add_f32 v[132:133], v[132:133], v[148:149]
    v_pk_add_f32 v[134:135], v[134:135], v[150:151]
    v_pk_add_f32 v[136:137], v[136:137], v[152:153]
    v_pk_add_f32 v[138:139], v[138:139], v[154:155]
    v_pk_add_f32 v[132:133], v[132:133], v[156:157]
    v_pk_add_f32 v[134:135], v[134:135], v[158:159]
    v_pk_add_f32 v[136:137], v[136:137], v[160:161]
    v_pk_add_f32 v[138:139], v[138:139], v[162:163]
    v_pk_add_f32 v[132:133], v[132:133], v[164:165]
    v_pk_add_f32 v[134:135], v[134:135], v[166:167]
    v_pk_add_f32 v[136:137], v[136:137], v[168:169]
    v_pk_add_f32 v[138:139], v[138:139], v[170:171]
    v_pk_add_f32 v[132:133], v[132:133], v[172:173]
    v_pk_add_f32 v[134:135], v[134:135], v[174:175]
    v_pk_add_f32 v[136:137], v[136:137], v[176:177]
    v_pk_add_f32 v[138:139], v[138:139], v[178:179]
    v_pk_add_f32 v[132:133], v[132:133], v[180:181]
    v_pk_add_f32 v[134:135], v[134:135], v[182:183]
    v_pk_add_f32 v[136:137], v[136:137], v[184:185]
    v_pk_add_f32 v[138:139], v[138:139], v[186:187]
    v_pk_add_f32 v[132:133], v[132:133], v[188:189]
    v_pk_add_f32 v[134:135], v[134:135], v[190:191]
    v_pk_add_f32 v[136:137], v[136:137], v[192:193]
    v_pk_add_f32 v[138:139], v[138:139], v[194:195]
    v_cvt_pk_bf16_f32 v132, v132, v133
    v_cvt_pk_bf16_f32 v133, v134, v135
    v_cvt_pk_bf16_f32 v134, v136, v137
    v_cvt_pk_bf16_f32 v135, v138, v139
    ds_write_b64 v10, v[132:133] offset:0
    ds_write_b64 v10, v[134:135] offset:32
    s_waitcnt lgkmcnt(0)
    ds_read_b128 v[136:139], v11 offset:0
    s_waitcnt lgkmcnt(0)
    buffer_store_dwordx4 v[136:139], v247, s[64:67], 0 offen offset:0
L_fin:
L_end:
    s_endpgm
L_code_end:
L_spin_n:
    s_mov_b32 s73, 300000
L_spin_n1:
    buffer_load_dwordx2 v[250:251], v9, s[60:63], 0 offen sc1
    s_sub_u32 s73, s73, 1
    s_waitcnt vmcnt(0)
    v_readfirstlane_b32 s96, v250
    v_readfirstlane_b32 s97, v251
    s_cmp_eq_u32 s73, 0
    s_cbranch_scc1 L_back_n
    s_nop 2
    s_cmp_eq_u64 s[96:97], 0
    s_cbranch_scc1 L_spin_n1
    s_branch L_back_n
L_redo:
    s_mov_b64 s[70:71], 0
    s_mov_b32 s68, 1
    s_waitcnt vmcnt(0) lgkmcnt(0)
    s_barrier
    v_lshl_add_u32 v4, s32, 2, v3
    v_xor_b32 v5, v2, v4
    v_lshlrev_b32 v5, 4, v5
    v_lshl_add_u32 v84, v4, 10, v5
    s_and_b32 s39, s32, 2
    s_lshl_b32 s39, s39, 2
    v_lshl_add_u32 v5, v3, 1, s39
    v_xor_b32 v5, v2, v5
    v_lshlrev_b32 v5, 4, v5
    v_lshl_add_u32 v85, v4, 13, v5
    s_nop 4
    s_branch L_restart
L_max:
    s_mov_b32 s73, m0
    s_waitcnt vmcnt(0) lgkmcnt(0)
    s_barrier
    v_mov_b32 v76, 0xff800000
    v_mov_b32 v77, 0xff800000
    v_mov_b32 v78, 0xff800000
    v_mov_b32 v79, 0xff800000
    v_mov_b32 v80, 0xff800000
    v_add_u32 v84, 98304, v10
    v_add_u32 v85, 98304, v11
    v_add_u32 v86, 98304, v12
    v_add_u32 v87, 98304, v13
    s_mov_b32 s41, 0
L_max_loop:
    s_add_u32 s40, s41, 0
    s_add_u32 m0, s37, 98304
    s_nop 0
    buffer_load_dwordx4 v22, s[12:15], s40 offen offset:0 lds
    buffer_load_dwordx4 v23, s[12:15], s40 offen offset:1024 lds
    buffer_load_dwordx4 v24, s[12:15], s40 offen offset:2048 lds
    buffer_load_dwordx4 v25, s[12:15], s40 offen offset:3072 lds
    s_add_u32 s40, s41, 4096
    s_add_u32 m0, s37, 102400
    s_nop 0
    buffer_load_dwordx4 v22, s[12:15], s40 offen offset:0 lds
    buffer_load_dwordx4 v23, s[12:15], s40 offen offset:1024 lds
    buffer_load_dwordx4 v24, s[12:15], s40 offen offset:2048 lds
    buffer_load_dwordx4 v25, s[12:15], s40 offen offset:3072 lds
    s_waitcnt vmcnt(0)
    ds_read_b128 v[164:167], v84 offset:0
    ds_read_b128 v[168:171], v85 offset:0
    ds_read_b128 v[172:175], v86 offset:0
    ds_read_b128 v[176:179], v87 offset:0
    ds_read_b128 v[180:183], v84 offset:4096
    ds_read_b128 v[184:187], v85 offset:4096
    ds_read_b128 v[188:191], v86 offset:4096
    ds_read_b128 v[192:195], v87 offset:4096
    s_waitcnt lgkmcnt(7)
    v_mfma_f32_16x16x32_bf16 v[88:91], v[164:167], a[160:163], 0
    s_waitcnt lgkmcnt(6)
    v_mfma_f32_16x16x32_bf16 v[88:91], v[168:171], a[164:167], v[88:91]
    s_waitcnt lgkmcnt(5)
    v_mfma_f32_16x16x32_bf16 v[88:91], v[172:175], a[168:171], v[88:91]
    s_waitcnt lgkmcnt(4)
    v_mfma_f32_16x16x32_bf16 v[88:91], v[176:179], a[172:175], v[88:91]
    s_waitcnt lgkmcnt(3)
    v_mfma_f32_16x16x32_bf16 v[92:95], v[180:183], a[160:163], 0
    s_waitcnt lgkmcnt(2)
    v_mfma_f32_16x16x32_bf16 v[92:95], v[184:187], a[164:167], v[92:95]
    s_waitcnt lgkmcnt(1)
    v_mfma_f32_16x16x32_bf16 v[92:95], v[188:191], a[168:171], v[92:95]
    s_waitcnt lgkmcnt(0)
    v_mfma_f32_16x16x32_bf16 v[92:95], v[192:195], a[172:175], v[92:95]
    v_max3_f32 v76, v76, v88, v89
    v_max3_f32 v76, v76, v90, v91
    s_nop 5
    v_max3_f32 v76, v76, v92, v93
    v_max3_f32 v76, v76, v94, v95
    v_mfma_f32_16x16x32_bf16 v[88:91], v[164:167], a[176:179], 0
    v_mfma_f32_16x16x32_bf16 v[88:91], v[168:171], a[180:183], v[88:91]
    v_mfma_f32_16x16x32_bf16 v[88:91], v[172:175], a[184:187], v[88:91]
    v_mfma_f32_16x16x32_bf16 v[88:91], v[176:179], a[188:191], v[88:91]
    v_mfma_f32_16x16x32_bf16 v[92:95], v[180:183], a[176:179], 0
    v_mfma_f32_16x16x32_bf16 v[92:95], v[184:187], a[180:183], v[92:95]
    v_mfma_f32_16x16x32_bf16 v[92:95], v[188:191], a[184:187], v[92:95]
    v_mfma_f32_16x16x32_bf16 v[92:95], v[192:195], a[188:191], v[92:95]
    s_nop 3
    v_max3_f32 v77, v77, v88, v89
    v_max3_f32 v77, v77, v90, v91
    s_nop 1
    v_max3_f32 v77, v77, v92, v93
    v_max3_f32 v77, v77, v94, v95
    v_mfma_f32_16x16x32_bf16 v[88:91], v[164:167], a[192:195], 0
    v_mfma_f32_16x16x32_bf16 v[88:91], v[168:171], a[196:199], v[88:91]
    v_mfma_f32_16x16x32_bf16 v[88:91], v[172:175], a[200:203], v[88:91]
    v_mfma_f32_16x16x32_bf16 v[88:91], v[176:179], a[204:207], v[88:91]
    v_mfma_f32_16x16x32_bf16 v[92:95], v[180:183], a[192:195], 0
    v_mfma_f32_16x16x32_bf16 v[92:95], v[184:187], a[196:199], v[92:95]
    v_mfma_f32_16x16x32_bf16 v[92:95], v[188:191], a[200:203], v[92:95]
    v_mfma_f32_16x16x32_bf16 v[92:95], v[192:195], a[204:207], v[92:95]
    s_nop 3
    v_max3_f32 v78, v78, v88, v89
    v_max3_f32 v78, v78, v90, v91
    s_nop 1
    v_max3_f32 v78, v78, v92, v93
    v_max3_f32 v78, v78, v94, v95
    v_mfma_f32_16x16x32_bf16 v[88:91], v[164:167], a[208:211], 0
    v_mfma_f32_16x16x32_bf16 v[88:91], v[168:171], a[212:215], v[88:91]
    v_mfma_f32_16x16x32_bf16 v[88:91], v[172:175], a[216:219], v[88:91]
    v_mfma_f32_16x16x32_bf16 v[88:91], v[176:179], a[220:223], v[88:91]
    v_mfma_f32_16x16x32_bf16 v[92:95], v[180:183], a[208:211], 0
    v_mfma_f32_16x16x32_bf16 v[92:95], v[184:187], a[212:215], v[92:95]
    v_mfma_f32_16x16x32_bf16 v[92:95], v[188:191], a[216:219], v[92:95]
    v_mfma_f32_16x16x32_bf16 v[92:95], v[192:195], a[220:223], v[92:95]
    s_nop 3
    v_max3_f32 v79, v79, v88, v89
    v_max3_f32 v79, v79, v90, v91
    s_nop 1
    v_max3_f32 v79, v79, v92, v93
    v_max3_f32 v79, v79, v94, v95
    v_mfma_f32_16x16x32_bf16 v[88:91], v[164:167], a[224:227], 0
    v_mfma_f32_16x16x32_bf16 v[88:91], v[168:171], a[228:231], v[88:91]
    v_mfma_f32_16x16x32_bf16 v[88:91], v[172:175], a[232:235], v[88:91]
    v_mfma_f32_16x16x32_bf16 v[88:91], v[176:179], a[236:239], v[88:91]
    v_mfma_f32_16x16x32_bf16 v[92:95], v[180:183], a[224:227], 0
    v_mfma_f32_16x16x32_bf16 v[92:95], v[184:187], a[228:231], v[92:95]
    v_mfma_f32_16x16x32_bf16 v[92:95], v[188:191], a[232:235], v[92:95]
    v_mfma_f32_16x16x32_bf16 v[92:95], v[192:195], a[236:239], v[92:95]
    s_nop 3
    v_max3_f32 v80, v80, v88, v89
    v_max3_f32 v80, v80, v90, v91
    s_nop 1
    v_max3_f32 v80, v80, v92, v93
    v_max3_f32 v80, v80, v94, v95
    s_waitcnt vmcnt(0) lgkmcnt(0)
    s_add_u32 s41, s41, 8192
    s_cmp_lt_u32 s41, 65536
    s_nop 4
    s_cbranch_scc1 L_max_loop
    s_barrier
    s_mul_i32 s39, s32, 1280
    s_add_u32 s39, s39, 98304
    v_lshl_add_u32 v84, v1, 2, s39
    s_mov_b32 s39, 98304
    v_lshl_add_u32 v85, v2, 2, s39
    ds_write_b32 v84, v76 offset:0
    ds_write_b32 v84, v77 offset:256
    ds_write_b32 v84, v78 offset:512
    ds_write_b32 v84, v79 offset:768
    ds_write_b32 v84, v80 offset:1024
    s_waitcnt lgkmcnt(0)
    s_barrier
    ds_read_b32 v164, v85 offset:0
    ds_read_b32 v165, v85 offset:64
    ds_read_b32 v166, v85 offset:128
    ds_read_b32 v167, v85 offset:192
    ds_read_b32 v168, v85 offset:1280
    ds_read_b32 v169, v85 offset:1344
    ds_read_b32 v170, v85 offset:1408
    ds_read_b32 v171, v85 offset:1472
    ds_read_b32 v172, v85 offset:2560
    ds_read_b32 v173, v85 offset:2624
    ds_read_b32 v174, v85 offset:2688
    ds_read_b32 v175, v85 offset:2752
    ds_read_b32 v176, v85 offset:3840
    ds_read_b32 v177, v85 offset:3904
    ds_read_b32 v178, v85 offset:3968
    ds_read_b32 v179, v85 offset:4032
    s_waitcnt lgkmcnt(14)
    v_max3_f32 v76, v76, v164, v165
    s_waitcnt lgkmcnt(12)
    v_max3_f32 v76, v76, v166, v167
    s_waitcnt lgkmcnt(10)
    v_max3_f32 v76, v76, v168, v169
    s_waitcnt lgkmcnt(8)
    v_max3_f32 v76, v76, v170, v171
    s_waitcnt lgkmcnt(6)
    v_max3_f32 v76, v76, v172, v173
    s_waitcnt lgkmcnt(4)
    v_max3_f32 v76, v76, v174, v175
    s_waitcnt lgkmcnt(2)
    v_max3_f32 v76, v76, v176, v177
    s_waitcnt lgkmcnt(0)
    v_max3_f32 v76, v76, v178, v179
    v_sub_f32 v36, 0, v76
    v_sub_f32 v37, 0, v76
    v_sub_f32 v38, 0, v76
    v_sub_f32 v39, 0, v76
    ds_read_b32 v164, v85 offset:256
    ds_read_b32 v165, v85 offset:320
    ds_read_b32 v166, v85 offset:384
    ds_read_b32 v167, v85 offset:448
    ds_read_b32 v168, v85 offset:1536
    ds_read_b32 v169, v85 offset:1600
    ds_read_b32 v170, v85 offset:1664
    ds_read_b32 v171, v85 offset:1728
    ds_read_b32 v172, v85 offset:2816
    ds_read_b32 v173, v85 offset:2880
    ds_read_b32 v174, v85 offset:2944
    ds_read_b32 v175, v85 offset:3008
    ds_read_b32 v176, v85 offset:4096
    ds_read_b32 v177, v85 offset:4160
    ds_read_b32 v178, v85 offset:4224
    ds_read_b32 v179, v85 offset:4288
    s_waitcnt lgkmcnt(14)
    v_max3_f32 v77, v77, v164, v165
    s_waitcnt lgkmcnt(12)
    v_max3_f32 v77, v77, v166, v167
    s_waitcnt lgkmcnt(10)
    v_max3_f32 v77, v77, v168, v169
    s_waitcnt lgkmcnt(8)
    v_max3_f32 v77, v77, v170, v171
    s_waitcnt lgkmcnt(6)
    v_max3_f32 v77, v77, v172, v173
    s_waitcnt lgkmcnt(4)
    v_max3_f32 v77, v77, v174, v175
    s_waitcnt lgkmcnt(2)
    v_max3_f32 v77, v77, v176, v177
    s_waitcnt lgkmcnt(0)
    v_max3_f32 v77, v77, v178, v179
    v_sub_f32 v40, 0, v77
    v_sub_f32 v41, 0, v77
    v_sub_f32 v42, 0, v77
    v_sub_f32 v43, 0, v77
    ds_read_b32 v164, v85 offset:512
    ds_read_b32 v165, v85 offset:576
    ds_read_b32 v166, v85 offset:640
    ds_read_b32 v167, v85 offset:704
    ds_read_b32 v168, v85 offset:1792
    ds_read_b32 v169, v85 offset:1856
    ds_read_b32 v170, v85 offset:1920
    ds_read_b32 v171, v85 offset:1984
    ds_read_b32 v172, v85 offset:3072
    ds_read_b32 v173, v85 offset:3136
    ds_read_b32 v174, v85 offset:3200
    ds_read_b32 v175, v85 offset:3264
    ds_read_b32 v176, v85 offset:4352
    ds_read_b32 v177, v85 offset:4416
    ds_read_b32 v178, v85 offset:4480
    ds_read_b32 v179, v85 offset:4544
    s_waitcnt lgkmcnt(14)
    v_max3_f32 v78, v78, v164, v165
    s_waitcnt lgkmcnt(12)
    v_max3_f32 v78, v78, v166, v167
    s_waitcnt lgkmcnt(10)
    v_max3_f32 v78, v78, v168, v169
    s_waitcnt lgkmcnt(8)
    v_max3_f32 v78, v78, v170, v171
    s_waitcnt lgkmcnt(6)
    v_max3_f32 v78, v78, v172, v173
    s_waitcnt lgkmcnt(4)
    v_max3_f32 v78, v78, v174, v175
    s_waitcnt lgkmcnt(2)
    v_max3_f32 v78, v78, v176, v177
    s_waitcnt lgkmcnt(0)
    v_max3_f32 v78, v78, v178, v179
    v_sub_f32 v44, 0, v78
    v_sub_f32 v45, 0, v78
    v_sub_f32 v46, 0, v78
    v_sub_f32 v47, 0, v78
    ds_read_b32 v164, v85 offset:768
    ds_read_b32 v165, v85 offset:832
    ds_read_b32 v166, v85 offset:896
    ds_read_b32 v167, v85 offset:960
    ds_read_b32 v168, v85 offset:2048
    ds_read_b32 v169, v85 offset:2112
    ds_read_b32 v170, v85 offset:2176
    ds_read_b32 v171, v85 offset:2240
    ds_read_b32 v172, v85 offset:3328
    ds_read_b32 v173, v85 offset:3392
    ds_read_b32 v174, v85 offset:3456
    ds_read_b32 v175, v85 offset:3520
    ds_read_b32 v176, v85 offset:4608
    ds_read_b32 v177, v85 offset:4672
    ds_read_b32 v178, v85 offset:4736
    ds_read_b32 v179, v85 offset:4800
    s_waitcnt lgkmcnt(14)
    v_max3_f32 v79, v79, v164, v165
    s_waitcnt lgkmcnt(12)
    v_max3_f32 v79, v79, v166, v167
    s_waitcnt lgkmcnt(10)
    v_max3_f32 v79, v79, v168, v169
    s_waitcnt lgkmcnt(8)
    v_max3_f32 v79, v79, v170, v171
    s_waitcnt lgkmcnt(6)
    v_max3_f32 v79, v79, v172, v173
    s_waitcnt lgkmcnt(4)
    v_max3_f32 v79, v79, v174, v175
    s_waitcnt lgkmcnt(2)
    v_max3_f32 v79, v79, v176, v177
    s_waitcnt lgkmcnt(0)
    v_max3_f32 v79, v79, v178, v179
    v_sub_f32 v48, 0, v79
    v_sub_f32 v49, 0, v79
    v_sub_f32 v50, 0, v79
    v_sub_f32 v51, 0, v79
    ds_read_b32 v164, v85 offset:1024
    ds_read_b32 v165, v85 offset:1088
    ds_read_b32 v166, v85 offset:1152
    ds_read_b32 v167, v85 offset:1216
    ds_read_b32 v168, v85 offset:2304
    ds_read_b32 v169, v85 offset:2368
    ds_read_b32 v170, v85 offset:2432
    ds_read_b32 v171, v85 offset:2496
    ds_read_b32 v172, v85 offset:3584
    ds_read_b32 v173, v85 offset:3648
    ds_read_b32 v174, v85 offset:3712
    ds_read_b32 v175, v85 offset:3776
    ds_read_b32 v176, v85 offset:4864
    ds_read_b32 v177, v85 offset:4928
    ds_read_b32 v178, v85 offset:4992
    ds_read_b32 v179, v85 offset:5056
    s_waitcnt lgkmcnt(14)
    v_max3_f32 v80, v80, v164, v165
    s_waitcnt lgkmcnt(12)
    v_max3_f32 v80, v80, v166, v167
    s_waitcnt lgkmcnt(10)
    v_max3_f32 v80, v80, v168, v169
    s_waitcnt lgkmcnt(8)
    v_max3_f32 v80, v80, v170, v171
    s_waitcnt lgkmcnt(6)
    v_max3_f32 v80, v80, v172, v173
    s_waitcnt lgkmcnt(4)
    v_max3_f32 v80, v80, v174, v175
    s_waitcnt lgkmcnt(2)
    v_max3_f32 v80, v80, v176, v177
    s_waitcnt lgkmcnt(0)
    v_max3_f32 v80, v80, v178, v179
    v_sub_f32 v52, 0, v80
    v_sub_f32 v53, 0, v80
    v_sub_f32 v54, 0, v80
    v_sub_f32 v55, 0, v80
    s_waitcnt vmcnt(0) lgkmcnt(0)
    s_barrier
    s_mov_b32 m0, s73
    s_nop 4
    s_branch L_back_max
.section .rodata,"a"
.p2align 6
.amdhsa_kernel standalone__gqa_block_cached__near_ridge_kernel
  .amdhsa_next_free_vgpr 512
  .amdhsa_next_free_sgpr 102
  .amdhsa_accum_offset 256
  .amdhsa_group_segment_fixed_size 0
  .amdhsa_kernarg_size 64
  .amdhsa_user_sgpr_count 2
  .amdhsa_user_sgpr_kernarg_segment_ptr 1
  .amdhsa_system_sgpr_workgroup_id_x 1
  .amdhsa_float_denorm_mode_32 3
.end_amdhsa_kernel
```
